```python
import torch

def _softmax(x, axis=-1):
    return torch.softmax(x, dim=axis)
def _gelu(x):
    return torch.nn.functional.gelu(x, approximate="tanh")
def _silu(x):
    return torch.nn.functional.silu(x)
def _sigmoid(x):
    return torch.sigmoid(x)
def _layernorm(x, axis=-1, eps=1e-5):
    m = x.mean(dim=axis, keepdim=True)
    v = x.var(dim=axis, keepdim=True, unbiased=False)
    return (x - m) / torch.sqrt(v + eps)
def _scatter_add(tgt, idx, src, axis=0):
    return tgt.clone().index_add_(axis, idx, src)
def _segment_sum(src, seg, n):
    out = torch.zeros((n,) + src.shape[1:], dtype=src.dtype)
    return out.index_add_(0, seg, src)
def _pad(x, pw):
    flat = tuple(v for pair in reversed(pw) for v in pair)
    return torch.nn.functional.pad(x, flat)

kernel_name = 'standalone__dcn_v2_cross__recsys'

def setup_inputs():

    _w = (lambda a: (lambda t: t.to(torch.bfloat16) if t.is_floating_point() else t)(torch.as_tensor(a)))
    B, F, D, L = 4096, 26, 128, 6
    Din = min(F * D, 1024)
    return {
        "x0": _w((lambda *s: torch.randn(*s, dtype=torch.bfloat16) * 0.05)(B, Din)),
        "ws": _w((lambda *s: torch.randn(*s, dtype=torch.bfloat16) * 0.05)(L, Din, Din)),
        "bs": _w((lambda *s: torch.randn(*s, dtype=torch.bfloat16) * 0.05)(L, Din)),
    }

def reference(x0, ws, bs):
    x = x0
    for l in range(ws.shape[0]):
        x = x0 * (x @ ws[l] + bs[l]) + x
    return x
```

```asm
; @launch grid=(256,1,1) block=(512,1,1) lds=163840
.amdgcn_target "amdgcn-amd-amdhsa--gfx950"
.text
.globl standalone__dcn_v2_cross__recsys_kernel
.p2align 8
.type standalone__dcn_v2_cross__recsys_kernel,@function
standalone__dcn_v2_cross__recsys_kernel:
  s_cmp_ge_u32 s2, 256
  s_cbranch_scc1 L_end
  s_load_dwordx4 s[4:7], s[0:1], 0
  s_load_dwordx4 s[8:11], s[0:1], 16
  s_load_dwordx4 s[12:15], s[0:1], 32
  v_lshrrev_b32 v1, 6, v0
  v_and_b32 v252, 63, v0
  s_lshr_b32 s42, s2, 3
  v_readfirstlane_b32 s40, v1
  s_and_b32 s42, s42, 7
  s_and_b32 s41, s2, 7
  s_lshl_b32 s41, s41, 2
  s_lshr_b32 s43, s2, 6
  s_add_u32 s41, s41, s43
  s_and_b32 s38, s42, 3
  s_lshl_b32 s38, s38, 1
  s_add_u32 s38, s38, s41
  s_and_b32 s38, s38, 7
  s_and_b32 s39, s41, 3
  s_lshr_b32 s43, s41, 2
  s_add_u32 s39, s39, s43
  s_cmp_ge_u32 s39, 7
  s_cselect_b32 s43, 7, 0
  s_sub_u32 s39, s39, s43
  s_mov_b32 s96, s38
  s_mov_b32 s97, s39
  s_cmp_ge_u32 s40, 4
  s_cbranch_scc1 L_loader
  s_and_b32 s44, s40, 1
  s_lshr_b32 s45, s40, 1
  v_and_b32 v4, 127, v0
  v_lshrrev_b32 v5, 7, v0
  s_lshl_b32 s47, s42, 8
  v_lshlrev_b32 v6, 11, v5
  v_lshl_add_u32 v6, v4, 1, v6
  v_add_u32 v6, s47, v6
  s_waitcnt lgkmcnt(0)
  s_mov_b32 s32, s8
  s_and_b32 s33, s9, 0xffff
  s_mov_b32 s34, 12288
  s_mov_b32 s35, 0x00020000
  s_mov_b32 s24, s14
  s_and_b32 s25, s15, 0xffff
  s_mov_b32 s26, 268435456
  s_mov_b32 s27, 0x00020000
  s_mov_b32 s28, s10
  s_and_b32 s29, s11, 0xffff
  s_mov_b32 s30, 8388608
  s_mov_b32 s31, 0x00020000
  s_mov_b32 s36, s12
  s_and_b32 s37, s13, 0xffff
  s_mov_b32 s38, 256
  s_mov_b32 s39, 0x00020000
  buffer_load_ushort v8, v6, s[32:35], 0 offen
  v_add_u32 v6, 4096, v6
  buffer_load_ushort v9, v6, s[32:35], 0 offen
  v_add_u32 v6, 4096, v6
  buffer_load_ushort v10, v6, s[32:35], 0 offen
  s_lshl_b32 s51, s41, 8
  s_lshl_b32 s47, s42, 4
  s_add_u32 s51, s51, s47
  s_add_u32 s51, s51, 50331648
  s_getreg_b32 s54, hwreg(HW_REG_XCC_ID, 0, 3)
  s_lshl_b32 s54, s54, 2
  v_lshlrev_b32 v12, 2, v252
  v_mov_b32 v13, 0
  s_cmp_lg_u32 s40, 0
  s_cbranch_scc1 L_noreset
  s_mov_b64 exec, 0xf
  buffer_store_dword v13, v12, s[24:27], s51 offen sc1
  s_mov_b64 exec, -1
L_noreset:
  s_lshl_b32 s47, s40, 2
  s_add_u32 s51, s51, s47
  v_and_b32 v1, 15, v252
  v_lshrrev_b32 v2, 4, v252
  v_lshlrev_b32 v3, 11, v1
  v_lshl_add_u32 v253, v2, 3, v3
  s_lshl_b32 s46, s41, 7
  s_lshl_b32 s47, s45, 6
  s_add_u32 s46, s46, s47
  s_lshl_b32 s46, s46, 11
  s_lshl_b32 s47, s42, 8
  s_add_u32 s46, s46, s47
  s_lshl_b32 s47, s44, 7
  s_add_u32 s48, s46, s47
  v_bfe_u32 v15, v252, 2, 2
  v_and_b32 v16, 1, v2
  v_lshl_or_b32 v16, v16, 2, v15
  v_lshlrev_b32 v16, 5, v16
  v_lshl_add_u32 v17, v2, 3, v15
  v_lshlrev_b32 v17, 8, v17
  v_and_b32 v18, 3, v252
  v_lshl_add_u32 v17, v18, 3, v17
  v_add_u32 v17, 65536, v17
  s_lshl_b32 s46, s44, 7
  s_add_u32 s47, s46, 0
  v_xor_b32 v242, s47, v16
  v_add_u32 v242, v242, v17
  s_add_u32 s47, s46, 32
  v_xor_b32 v243, s47, v16
  v_add_u32 v243, v243, v17
  s_add_u32 s47, s46, 64
  v_xor_b32 v244, s47, v16
  v_add_u32 v244, v244, v17
  s_add_u32 s47, s46, 96
  v_xor_b32 v245, s47, v16
  v_add_u32 v245, v245, v17
  v_and_b32 v4, 7, v1
  s_lshl_b32 s46, s45, 13
  v_lshlrev_b32 v5, 7, v1
  v_add_u32 v5, s46, v5
  v_add_u32 v6, 0, v2
  v_xor_b32 v6, v6, v4
  v_lshl_add_u32 v240, v6, 4, v5
  v_add_u32 v6, 4, v2
  v_xor_b32 v6, v6, v4
  v_lshl_add_u32 v241, v6, 4, v5
  v_lshlrev_b32 v250, 4, v252
  s_lshl_b32 s46, s44, 8
  s_add_u32 s46, s46, 131072
  v_lshl_add_u32 v251, v2, 4, s46
  v_mov_b32 v128, 0
  v_mov_b32 v129, 0
  v_mov_b32 v130, 0
  v_mov_b32 v131, 0
  v_mov_b32 v132, 0
  v_mov_b32 v133, 0
  v_mov_b32 v134, 0
  v_mov_b32 v135, 0
  v_mov_b32 v136, 0
  v_mov_b32 v137, 0
  v_mov_b32 v138, 0
  v_mov_b32 v139, 0
  v_mov_b32 v140, 0
  v_mov_b32 v141, 0
  v_mov_b32 v142, 0
  v_mov_b32 v143, 0
  v_mov_b32 v144, 0
  v_mov_b32 v145, 0
  v_mov_b32 v146, 0
  v_mov_b32 v147, 0
  v_mov_b32 v148, 0
  v_mov_b32 v149, 0
  v_mov_b32 v150, 0
  v_mov_b32 v151, 0
  v_mov_b32 v152, 0
  v_mov_b32 v153, 0
  v_mov_b32 v154, 0
  v_mov_b32 v155, 0
  v_mov_b32 v156, 0
  v_mov_b32 v157, 0
  v_mov_b32 v158, 0
  v_mov_b32 v159, 0
  v_mov_b32 v160, 0
  v_mov_b32 v161, 0
  v_mov_b32 v162, 0
  v_mov_b32 v163, 0
  v_mov_b32 v164, 0
  v_mov_b32 v165, 0
  v_mov_b32 v166, 0
  v_mov_b32 v167, 0
  v_mov_b32 v168, 0
  v_mov_b32 v169, 0
  v_mov_b32 v170, 0
  v_mov_b32 v171, 0
  v_mov_b32 v172, 0
  v_mov_b32 v173, 0
  v_mov_b32 v174, 0
  v_mov_b32 v175, 0
  v_mov_b32 v176, 0
  v_mov_b32 v177, 0
  v_mov_b32 v178, 0
  v_mov_b32 v179, 0
  v_mov_b32 v180, 0
  v_mov_b32 v181, 0
  v_mov_b32 v182, 0
  v_mov_b32 v183, 0
  v_mov_b32 v184, 0
  v_mov_b32 v185, 0
  v_mov_b32 v186, 0
  v_mov_b32 v187, 0
  v_mov_b32 v188, 0
  v_mov_b32 v189, 0
  v_mov_b32 v190, 0
  v_mov_b32 v191, 0
  v_and_b32 v19, 15, v252
  s_lshl_b32 s46, s42, 4
  v_add_u32 v19, s46, v19
  v_lshlrev_b32 v19, 11, v19
  v_lshrrev_b32 v20, 4, v252
  s_lshl_b32 s46, s40, 2
  v_add_u32 v20, s46, v20
  v_lshl_add_u32 v19, v20, 7, v19
  v_lshrrev_b32 v20, 1, v252
  s_and_b32 s46, s41, 3
  s_lshl_b32 s46, s46, 5
  v_add_u32 v20, s46, v20
  v_lshlrev_b32 v20, 11, v20
  v_and_b32 v21, 1, v252
  v_lshl_add_u32 v20, v21, 7, v20
  s_lshl_b32 s46, s42, 8
  v_add_u32 v20, s46, v20
  s_waitcnt vmcnt(0)
  s_cmp_lg_u32 s40, 0
  s_cbranch_scc1 L_noarrive
  s_lshl_b32 s46, s41, 2
  s_add_u32 s46, s46, 128
  s_lshl_b32 s47, 1, s54
  v_mov_b32 v13, s47
  s_mov_b64 exec, 1
  buffer_atomic_add v13, v12, s[36:39], s46 offen sc1
  s_mov_b64 exec, -1
L_noarrive:
  v_mov_b32 v252, v20
  v_lshlrev_b32 v7, 2, v0
  v_add_u32 v7, 131072, v7
  v_lshlrev_b32 v8, 16, v8
  v_lshlrev_b32 v9, 16, v9
  v_lshlrev_b32 v10, 16, v10
  v_cmp_gt_u32 vcc, 128, v0
  v_add_f32 v11, 1.0, v8
  s_nop 0
  v_cndmask_b32 v8, v8, v11, vcc
  ds_write_b32 v7, v8 offset:0
  ds_write_b32 v7, v9 offset:1024
  ds_write_b32 v7, v10 offset:2048
  s_waitcnt lgkmcnt(0)
  s_barrier
  s_mov_b32 s49, 0
  s_mov_b32 s55, 0
  s_mov_b32 s58, 0
  s_mov_b32 s59, 1
  s_sub_u32 s57, s42, s96
  s_and_b32 s57, s57, 7
  s_lshl_b32 s57, s57, 1
  s_add_u32 s57, s57, s44
  ds_read_b128 v[0:3], v251 offset:0
  ds_read_b128 v[4:7], v251 offset:64
  ds_read_b128 v[8:11], v251 offset:128
  ds_read_b128 v[12:15], v251 offset:192
  ds_read_b128 v[16:19], v251 offset:0
  ds_read_b128 v[20:23], v251 offset:64
  ds_read_b128 v[24:27], v251 offset:128
  ds_read_b128 v[28:31], v251 offset:192
  ds_read_b128 v[32:35], v251 offset:0
  ds_read_b128 v[36:39], v251 offset:64
  ds_read_b128 v[40:43], v251 offset:128
  ds_read_b128 v[44:47], v251 offset:192
  ds_read_b128 v[48:51], v251 offset:0
  ds_read_b128 v[52:55], v251 offset:64
  ds_read_b128 v[56:59], v251 offset:128
  ds_read_b128 v[60:63], v251 offset:192
  s_waitcnt lgkmcnt(0)
  ds_read_b64_tr_b16 v[208:209], v242 offset:0
  ds_read_b64_tr_b16 v[210:211], v242 offset:1024
  ds_read_b64_tr_b16 v[212:213], v243 offset:0
  ds_read_b64_tr_b16 v[214:215], v243 offset:1024
  ds_read_b64_tr_b16 v[216:217], v244 offset:0
  ds_read_b64_tr_b16 v[218:219], v244 offset:1024
  ds_read_b64_tr_b16 v[220:221], v245 offset:0
  ds_read_b64_tr_b16 v[222:223], v245 offset:1024
  ds_read_b128 v[192:195], v240 offset:0
  ds_read_b128 v[196:199], v240 offset:2048
  ds_read_b128 v[200:203], v240 offset:4096
  ds_read_b128 v[204:207], v240 offset:6144
  s_waitcnt lgkmcnt(0)
.p2align 6
L_layer0:
  s_mov_b32 s50, 0
L_iter0:
  s_cmp_lg_u32 s59, 0
  s_cbranch_scc1 L_x0special
L_nox0:
  s_waitcnt lgkmcnt(6)
  v_mfma_f32_16x16x32_bf16 v[0:3], v[208:211], v[192:195], v[0:3]
  ds_read_b64_tr_b16 v[224:225], v242 offset:8192
  v_mfma_f32_16x16x32_bf16 v[4:7], v[212:215], v[192:195], v[4:7]
  ds_read_b64_tr_b16 v[226:227], v242 offset:9216
  s_waitcnt lgkmcnt(3)
  v_mfma_f32_16x16x32_bf16 v[8:11], v[216:219], v[192:195], v[8:11]
  ds_read_b64_tr_b16 v[228:229], v243 offset:8192
  v_mfma_f32_16x16x32_bf16 v[12:15], v[220:223], v[192:195], v[12:15]
  ds_read_b64_tr_b16 v[230:231], v243 offset:9216
  v_mfma_f32_16x16x32_bf16 v[16:19], v[208:211], v[196:199], v[16:19]
  ds_read_b64_tr_b16 v[232:233], v244 offset:8192
  ds_read_b128 v[192:195], v241 offset:0
  v_mfma_f32_16x16x32_bf16 v[20:23], v[212:215], v[196:199], v[20:23]
  ds_read_b64_tr_b16 v[234:235], v244 offset:9216
  v_mfma_f32_16x16x32_bf16 v[24:27], v[216:219], v[196:199], v[24:27]
  ds_read_b64_tr_b16 v[236:237], v245 offset:8192
  v_mfma_f32_16x16x32_bf16 v[28:31], v[220:223], v[196:199], v[28:31]
  ds_read_b64_tr_b16 v[238:239], v245 offset:9216
  s_waitcnt lgkmcnt(9)
  v_mfma_f32_16x16x32_bf16 v[32:35], v[208:211], v[200:203], v[32:35]
  ds_read_b128 v[246:249], v241 offset:6144
  ds_read_b128 v[196:199], v241 offset:2048
  v_mfma_f32_16x16x32_bf16 v[36:39], v[212:215], v[200:203], v[36:39]
  v_mfma_f32_16x16x32_bf16 v[40:43], v[216:219], v[200:203], v[40:43]
  v_mfma_f32_16x16x32_bf16 v[44:47], v[220:223], v[200:203], v[44:47]
  v_mfma_f32_16x16x32_bf16 v[48:51], v[208:211], v[204:207], v[48:51]
  ds_read_b128 v[200:203], v241 offset:4096
  v_mfma_f32_16x16x32_bf16 v[52:55], v[212:215], v[204:207], v[52:55]
  v_mfma_f32_16x16x32_bf16 v[56:59], v[216:219], v[204:207], v[56:59]
  s_cmp_eq_u32 s57, 0
  s_cbranch_scc1 L_x0rd0
L_x0ret0:
  v_mfma_f32_16x16x32_bf16 v[60:63], v[220:223], v[204:207], v[60:63]
  s_waitcnt lgkmcnt(0)
  v_mfma_f32_16x16x32_bf16 v[0:3], v[224:227], v[192:195], v[0:3]
  s_barrier
  ds_read_b64_tr_b16 v[208:209], v242 offset:16384
  v_mfma_f32_16x16x32_bf16 v[4:7], v[228:231], v[192:195], v[4:7]
  ds_read_b64_tr_b16 v[210:211], v242 offset:17408
  v_mfma_f32_16x16x32_bf16 v[8:11], v[232:235], v[192:195], v[8:11]
  ds_read_b64_tr_b16 v[212:213], v243 offset:16384
  v_mfma_f32_16x16x32_bf16 v[12:15], v[236:239], v[192:195], v[12:15]
  ds_read_b64_tr_b16 v[214:215], v243 offset:17408
  v_mfma_f32_16x16x32_bf16 v[16:19], v[224:227], v[196:199], v[16:19]
  ds_read_b64_tr_b16 v[216:217], v244 offset:16384
  ds_read_b128 v[192:195], v240 offset:16384
  v_mfma_f32_16x16x32_bf16 v[20:23], v[228:231], v[196:199], v[20:23]
  ds_read_b64_tr_b16 v[218:219], v244 offset:17408
  v_mfma_f32_16x16x32_bf16 v[24:27], v[232:235], v[196:199], v[24:27]
  ds_read_b64_tr_b16 v[220:221], v245 offset:16384
  v_mfma_f32_16x16x32_bf16 v[28:31], v[236:239], v[196:199], v[28:31]
  ds_read_b64_tr_b16 v[222:223], v245 offset:17408
  v_mfma_f32_16x16x32_bf16 v[32:35], v[224:227], v[200:203], v[32:35]
  ds_read_b128 v[204:207], v240 offset:22528
  ds_read_b128 v[196:199], v240 offset:18432
  v_mfma_f32_16x16x32_bf16 v[36:39], v[228:231], v[200:203], v[36:39]
  v_mfma_f32_16x16x32_bf16 v[40:43], v[232:235], v[200:203], v[40:43]
  v_mfma_f32_16x16x32_bf16 v[44:47], v[236:239], v[200:203], v[44:47]
  v_mfma_f32_16x16x32_bf16 v[48:51], v[224:227], v[246:249], v[48:51]
  ds_read_b128 v[200:203], v240 offset:20480
  v_mfma_f32_16x16x32_bf16 v[52:55], v[228:231], v[246:249], v[52:55]
  v_mfma_f32_16x16x32_bf16 v[56:59], v[232:235], v[246:249], v[56:59]
  v_mfma_f32_16x16x32_bf16 v[60:63], v[236:239], v[246:249], v[60:63]
  s_waitcnt lgkmcnt(6)
  v_mfma_f32_16x16x32_bf16 v[0:3], v[208:211], v[192:195], v[0:3]
  ds_read_b64_tr_b16 v[224:225], v242 offset:24576
  v_mfma_f32_16x16x32_bf16 v[4:7], v[212:215], v[192:195], v[4:7]
  ds_read_b64_tr_b16 v[226:227], v242 offset:25600
  s_waitcnt lgkmcnt(3)
  v_mfma_f32_16x16x32_bf16 v[8:11], v[216:219], v[192:195], v[8:11]
  ds_read_b64_tr_b16 v[228:229], v243 offset:24576
  v_mfma_f32_16x16x32_bf16 v[12:15], v[220:223], v[192:195], v[12:15]
  ds_read_b64_tr_b16 v[230:231], v243 offset:25600
  v_mfma_f32_16x16x32_bf16 v[16:19], v[208:211], v[196:199], v[16:19]
  ds_read_b64_tr_b16 v[232:233], v244 offset:24576
  ds_read_b128 v[192:195], v241 offset:16384
  v_mfma_f32_16x16x32_bf16 v[20:23], v[212:215], v[196:199], v[20:23]
  ds_read_b64_tr_b16 v[234:235], v244 offset:25600
  v_mfma_f32_16x16x32_bf16 v[24:27], v[216:219], v[196:199], v[24:27]
  ds_read_b64_tr_b16 v[236:237], v245 offset:24576
  v_mfma_f32_16x16x32_bf16 v[28:31], v[220:223], v[196:199], v[28:31]
  ds_read_b64_tr_b16 v[238:239], v245 offset:25600
  s_waitcnt lgkmcnt(9)
  v_mfma_f32_16x16x32_bf16 v[32:35], v[208:211], v[200:203], v[32:35]
  ds_read_b128 v[246:249], v241 offset:22528
  ds_read_b128 v[196:199], v241 offset:18432
  v_mfma_f32_16x16x32_bf16 v[36:39], v[212:215], v[200:203], v[36:39]
  v_mfma_f32_16x16x32_bf16 v[40:43], v[216:219], v[200:203], v[40:43]
  v_mfma_f32_16x16x32_bf16 v[44:47], v[220:223], v[200:203], v[44:47]
  v_mfma_f32_16x16x32_bf16 v[48:51], v[208:211], v[204:207], v[48:51]
  ds_read_b128 v[200:203], v241 offset:20480
  v_mfma_f32_16x16x32_bf16 v[52:55], v[212:215], v[204:207], v[52:55]
  v_mfma_f32_16x16x32_bf16 v[56:59], v[216:219], v[204:207], v[56:59]
  s_cmp_eq_u32 s57, 1
  s_cbranch_scc1 L_x0rd1
L_x0ret1:
  v_mfma_f32_16x16x32_bf16 v[60:63], v[220:223], v[204:207], v[60:63]
  s_waitcnt lgkmcnt(0)
  v_mfma_f32_16x16x32_bf16 v[0:3], v[224:227], v[192:195], v[0:3]
  s_barrier
  ds_read_b64_tr_b16 v[208:209], v242 offset:32768
  v_mfma_f32_16x16x32_bf16 v[4:7], v[228:231], v[192:195], v[4:7]
  ds_read_b64_tr_b16 v[210:211], v242 offset:33792
  v_mfma_f32_16x16x32_bf16 v[8:11], v[232:235], v[192:195], v[8:11]
  ds_read_b64_tr_b16 v[212:213], v243 offset:32768
  v_mfma_f32_16x16x32_bf16 v[12:15], v[236:239], v[192:195], v[12:15]
  ds_read_b64_tr_b16 v[214:215], v243 offset:33792
  v_mfma_f32_16x16x32_bf16 v[16:19], v[224:227], v[196:199], v[16:19]
  ds_read_b64_tr_b16 v[216:217], v244 offset:32768
  ds_read_b128 v[192:195], v240 offset:32768
  v_mfma_f32_16x16x32_bf16 v[20:23], v[228:231], v[196:199], v[20:23]
  ds_read_b64_tr_b16 v[218:219], v244 offset:33792
  v_mfma_f32_16x16x32_bf16 v[24:27], v[232:235], v[196:199], v[24:27]
  ds_read_b64_tr_b16 v[220:221], v245 offset:32768
  v_mfma_f32_16x16x32_bf16 v[28:31], v[236:239], v[196:199], v[28:31]
  ds_read_b64_tr_b16 v[222:223], v245 offset:33792
  v_mfma_f32_16x16x32_bf16 v[32:35], v[224:227], v[200:203], v[32:35]
  ds_read_b128 v[204:207], v240 offset:38912
  ds_read_b128 v[196:199], v240 offset:34816
  v_mfma_f32_16x16x32_bf16 v[36:39], v[228:231], v[200:203], v[36:39]
  v_mfma_f32_16x16x32_bf16 v[40:43], v[232:235], v[200:203], v[40:43]
  v_mfma_f32_16x16x32_bf16 v[44:47], v[236:239], v[200:203], v[44:47]
  v_mfma_f32_16x16x32_bf16 v[48:51], v[224:227], v[246:249], v[48:51]
  ds_read_b128 v[200:203], v240 offset:36864
  v_mfma_f32_16x16x32_bf16 v[52:55], v[228:231], v[246:249], v[52:55]
  v_mfma_f32_16x16x32_bf16 v[56:59], v[232:235], v[246:249], v[56:59]
  v_mfma_f32_16x16x32_bf16 v[60:63], v[236:239], v[246:249], v[60:63]
  s_waitcnt lgkmcnt(6)
  v_mfma_f32_16x16x32_bf16 v[0:3], v[208:211], v[192:195], v[0:3]
  ds_read_b64_tr_b16 v[224:225], v242 offset:40960
  v_mfma_f32_16x16x32_bf16 v[4:7], v[212:215], v[192:195], v[4:7]
  ds_read_b64_tr_b16 v[226:227], v242 offset:41984
  s_waitcnt lgkmcnt(3)
  v_mfma_f32_16x16x32_bf16 v[8:11], v[216:219], v[192:195], v[8:11]
  ds_read_b64_tr_b16 v[228:229], v243 offset:40960
  v_mfma_f32_16x16x32_bf16 v[12:15], v[220:223], v[192:195], v[12:15]
  ds_read_b64_tr_b16 v[230:231], v243 offset:41984
  v_mfma_f32_16x16x32_bf16 v[16:19], v[208:211], v[196:199], v[16:19]
  ds_read_b64_tr_b16 v[232:233], v244 offset:40960
  ds_read_b128 v[192:195], v241 offset:32768
  v_mfma_f32_16x16x32_bf16 v[20:23], v[212:215], v[196:199], v[20:23]
  ds_read_b64_tr_b16 v[234:235], v244 offset:41984
  v_mfma_f32_16x16x32_bf16 v[24:27], v[216:219], v[196:199], v[24:27]
  ds_read_b64_tr_b16 v[236:237], v245 offset:40960
  v_mfma_f32_16x16x32_bf16 v[28:31], v[220:223], v[196:199], v[28:31]
  ds_read_b64_tr_b16 v[238:239], v245 offset:41984
  s_waitcnt lgkmcnt(9)
  v_mfma_f32_16x16x32_bf16 v[32:35], v[208:211], v[200:203], v[32:35]
  ds_read_b128 v[246:249], v241 offset:38912
  ds_read_b128 v[196:199], v241 offset:34816
  v_mfma_f32_16x16x32_bf16 v[36:39], v[212:215], v[200:203], v[36:39]
  v_mfma_f32_16x16x32_bf16 v[40:43], v[216:219], v[200:203], v[40:43]
  v_mfma_f32_16x16x32_bf16 v[44:47], v[220:223], v[200:203], v[44:47]
  v_mfma_f32_16x16x32_bf16 v[48:51], v[208:211], v[204:207], v[48:51]
  ds_read_b128 v[200:203], v241 offset:36864
  v_mfma_f32_16x16x32_bf16 v[52:55], v[212:215], v[204:207], v[52:55]
  v_mfma_f32_16x16x32_bf16 v[56:59], v[216:219], v[204:207], v[56:59]
  s_cmp_eq_u32 s57, 2
  s_cbranch_scc1 L_x0rd2
L_x0ret2:
  v_mfma_f32_16x16x32_bf16 v[60:63], v[220:223], v[204:207], v[60:63]
  s_cmp_eq_u32 s50, 3
  s_cbranch_scc1 L_tail
  s_waitcnt lgkmcnt(0)
  v_mfma_f32_16x16x32_bf16 v[0:3], v[224:227], v[192:195], v[0:3]
  s_barrier
  ds_read_b64_tr_b16 v[208:209], v242 offset:49152
  v_mfma_f32_16x16x32_bf16 v[4:7], v[228:231], v[192:195], v[4:7]
  ds_read_b64_tr_b16 v[210:211], v242 offset:50176
  v_mfma_f32_16x16x32_bf16 v[8:11], v[232:235], v[192:195], v[8:11]
  ds_read_b64_tr_b16 v[212:213], v243 offset:49152
  v_mfma_f32_16x16x32_bf16 v[12:15], v[236:239], v[192:195], v[12:15]
  ds_read_b64_tr_b16 v[214:215], v243 offset:50176
  v_mfma_f32_16x16x32_bf16 v[16:19], v[224:227], v[196:199], v[16:19]
  ds_read_b64_tr_b16 v[216:217], v244 offset:49152
  ds_read_b128 v[192:195], v240 offset:49152
  v_mfma_f32_16x16x32_bf16 v[20:23], v[228:231], v[196:199], v[20:23]
  ds_read_b64_tr_b16 v[218:219], v244 offset:50176
  v_mfma_f32_16x16x32_bf16 v[24:27], v[232:235], v[196:199], v[24:27]
  ds_read_b64_tr_b16 v[220:221], v245 offset:49152
  v_mfma_f32_16x16x32_bf16 v[28:31], v[236:239], v[196:199], v[28:31]
  ds_read_b64_tr_b16 v[222:223], v245 offset:50176
  v_mfma_f32_16x16x32_bf16 v[32:35], v[224:227], v[200:203], v[32:35]
  ds_read_b128 v[204:207], v240 offset:55296
  ds_read_b128 v[196:199], v240 offset:51200
  v_mfma_f32_16x16x32_bf16 v[36:39], v[228:231], v[200:203], v[36:39]
  v_mfma_f32_16x16x32_bf16 v[40:43], v[232:235], v[200:203], v[40:43]
  v_mfma_f32_16x16x32_bf16 v[44:47], v[236:239], v[200:203], v[44:47]
  v_mfma_f32_16x16x32_bf16 v[48:51], v[224:227], v[246:249], v[48:51]
  ds_read_b128 v[200:203], v240 offset:53248
  v_mfma_f32_16x16x32_bf16 v[52:55], v[228:231], v[246:249], v[52:55]
  v_mfma_f32_16x16x32_bf16 v[56:59], v[232:235], v[246:249], v[56:59]
  v_mfma_f32_16x16x32_bf16 v[60:63], v[236:239], v[246:249], v[60:63]
  s_waitcnt lgkmcnt(6)
  v_mfma_f32_16x16x32_bf16 v[0:3], v[208:211], v[192:195], v[0:3]
  ds_read_b64_tr_b16 v[224:225], v242 offset:57344
  v_mfma_f32_16x16x32_bf16 v[4:7], v[212:215], v[192:195], v[4:7]
  ds_read_b64_tr_b16 v[226:227], v242 offset:58368
  s_waitcnt lgkmcnt(3)
  v_mfma_f32_16x16x32_bf16 v[8:11], v[216:219], v[192:195], v[8:11]
  ds_read_b64_tr_b16 v[228:229], v243 offset:57344
  v_mfma_f32_16x16x32_bf16 v[12:15], v[220:223], v[192:195], v[12:15]
  ds_read_b64_tr_b16 v[230:231], v243 offset:58368
  v_mfma_f32_16x16x32_bf16 v[16:19], v[208:211], v[196:199], v[16:19]
  ds_read_b64_tr_b16 v[232:233], v244 offset:57344
  ds_read_b128 v[192:195], v241 offset:49152
  v_mfma_f32_16x16x32_bf16 v[20:23], v[212:215], v[196:199], v[20:23]
  ds_read_b64_tr_b16 v[234:235], v244 offset:58368
  v_mfma_f32_16x16x32_bf16 v[24:27], v[216:219], v[196:199], v[24:27]
  ds_read_b64_tr_b16 v[236:237], v245 offset:57344
  v_mfma_f32_16x16x32_bf16 v[28:31], v[220:223], v[196:199], v[28:31]
  ds_read_b64_tr_b16 v[238:239], v245 offset:58368
  s_waitcnt lgkmcnt(9)
  v_mfma_f32_16x16x32_bf16 v[32:35], v[208:211], v[200:203], v[32:35]
  ds_read_b128 v[246:249], v241 offset:55296
  ds_read_b128 v[196:199], v241 offset:51200
  v_mfma_f32_16x16x32_bf16 v[36:39], v[212:215], v[200:203], v[36:39]
  v_mfma_f32_16x16x32_bf16 v[40:43], v[216:219], v[200:203], v[40:43]
  v_mfma_f32_16x16x32_bf16 v[44:47], v[220:223], v[200:203], v[44:47]
  v_mfma_f32_16x16x32_bf16 v[48:51], v[208:211], v[204:207], v[48:51]
  ds_read_b128 v[200:203], v241 offset:53248
  v_mfma_f32_16x16x32_bf16 v[52:55], v[212:215], v[204:207], v[52:55]
  v_mfma_f32_16x16x32_bf16 v[56:59], v[216:219], v[204:207], v[56:59]
  s_cmp_eq_u32 s57, 3
  s_cbranch_scc1 L_x0rd3
L_x0ret3:
  v_mfma_f32_16x16x32_bf16 v[60:63], v[220:223], v[204:207], v[60:63]
  s_waitcnt lgkmcnt(0)
  v_mfma_f32_16x16x32_bf16 v[0:3], v[224:227], v[192:195], v[0:3]
  s_barrier
  ds_read_b64_tr_b16 v[208:209], v242 offset:0
  v_mfma_f32_16x16x32_bf16 v[4:7], v[228:231], v[192:195], v[4:7]
  ds_read_b64_tr_b16 v[210:211], v242 offset:1024
  v_mfma_f32_16x16x32_bf16 v[8:11], v[232:235], v[192:195], v[8:11]
  ds_read_b64_tr_b16 v[212:213], v243 offset:0
  v_mfma_f32_16x16x32_bf16 v[12:15], v[236:239], v[192:195], v[12:15]
  ds_read_b64_tr_b16 v[214:215], v243 offset:1024
  v_mfma_f32_16x16x32_bf16 v[16:19], v[224:227], v[196:199], v[16:19]
  ds_read_b64_tr_b16 v[216:217], v244 offset:0
  ds_read_b128 v[192:195], v240 offset:0
  v_mfma_f32_16x16x32_bf16 v[20:23], v[228:231], v[196:199], v[20:23]
  ds_read_b64_tr_b16 v[218:219], v244 offset:1024
  v_mfma_f32_16x16x32_bf16 v[24:27], v[232:235], v[196:199], v[24:27]
  ds_read_b64_tr_b16 v[220:221], v245 offset:0
  v_mfma_f32_16x16x32_bf16 v[28:31], v[236:239], v[196:199], v[28:31]
  ds_read_b64_tr_b16 v[222:223], v245 offset:1024
  v_mfma_f32_16x16x32_bf16 v[32:35], v[224:227], v[200:203], v[32:35]
  ds_read_b128 v[204:207], v240 offset:6144
  ds_read_b128 v[196:199], v240 offset:2048
  v_mfma_f32_16x16x32_bf16 v[36:39], v[228:231], v[200:203], v[36:39]
  v_mfma_f32_16x16x32_bf16 v[40:43], v[232:235], v[200:203], v[40:43]
  v_mfma_f32_16x16x32_bf16 v[44:47], v[236:239], v[200:203], v[44:47]
  v_mfma_f32_16x16x32_bf16 v[48:51], v[224:227], v[246:249], v[48:51]
  ds_read_b128 v[200:203], v240 offset:4096
  v_mfma_f32_16x16x32_bf16 v[52:55], v[228:231], v[246:249], v[52:55]
  v_mfma_f32_16x16x32_bf16 v[56:59], v[232:235], v[246:249], v[56:59]
  v_mfma_f32_16x16x32_bf16 v[60:63], v[236:239], v[246:249], v[60:63]
  s_add_u32 s50, s50, 1
  s_sub_u32 s57, s57, 4
  s_branch L_iter0
.p2align 6
L_layer:
  s_mov_b32 s50, 0
L_iter:
  s_waitcnt lgkmcnt(6)
  v_mfma_f32_16x16x32_bf16 v[0:3], v[208:211], v[192:195], v[0:3]
  ds_read_b64_tr_b16 v[224:225], v242 offset:8192
  v_mfma_f32_16x16x32_bf16 v[4:7], v[212:215], v[192:195], v[4:7]
  ds_read_b64_tr_b16 v[226:227], v242 offset:9216
  s_waitcnt lgkmcnt(3)
  v_mfma_f32_16x16x32_bf16 v[8:11], v[216:219], v[192:195], v[8:11]
  ds_read_b64_tr_b16 v[228:229], v243 offset:8192
  v_mfma_f32_16x16x32_bf16 v[12:15], v[220:223], v[192:195], v[12:15]
  ds_read_b64_tr_b16 v[230:231], v243 offset:9216
  v_mfma_f32_16x16x32_bf16 v[16:19], v[208:211], v[196:199], v[16:19]
  ds_read_b64_tr_b16 v[232:233], v244 offset:8192
  ds_read_b128 v[192:195], v241 offset:0
  v_mfma_f32_16x16x32_bf16 v[20:23], v[212:215], v[196:199], v[20:23]
  ds_read_b64_tr_b16 v[234:235], v244 offset:9216
  v_mfma_f32_16x16x32_bf16 v[24:27], v[216:219], v[196:199], v[24:27]
  ds_read_b64_tr_b16 v[236:237], v245 offset:8192
  v_mfma_f32_16x16x32_bf16 v[28:31], v[220:223], v[196:199], v[28:31]
  ds_read_b64_tr_b16 v[238:239], v245 offset:9216
  s_waitcnt lgkmcnt(9)
  v_mfma_f32_16x16x32_bf16 v[32:35], v[208:211], v[200:203], v[32:35]
  ds_read_b128 v[246:249], v241 offset:6144
  ds_read_b128 v[196:199], v241 offset:2048
  v_mfma_f32_16x16x32_bf16 v[36:39], v[212:215], v[200:203], v[36:39]
  v_mfma_f32_16x16x32_bf16 v[40:43], v[216:219], v[200:203], v[40:43]
  v_mfma_f32_16x16x32_bf16 v[44:47], v[220:223], v[200:203], v[44:47]
  v_mfma_f32_16x16x32_bf16 v[48:51], v[208:211], v[204:207], v[48:51]
  ds_read_b128 v[200:203], v241 offset:4096
  v_mfma_f32_16x16x32_bf16 v[52:55], v[212:215], v[204:207], v[52:55]
  v_mfma_f32_16x16x32_bf16 v[56:59], v[216:219], v[204:207], v[56:59]
  v_mfma_f32_16x16x32_bf16 v[60:63], v[220:223], v[204:207], v[60:63]
  s_waitcnt lgkmcnt(0)
  v_mfma_f32_16x16x32_bf16 v[0:3], v[224:227], v[192:195], v[0:3]
  s_barrier
  ds_read_b64_tr_b16 v[208:209], v242 offset:16384
  v_mfma_f32_16x16x32_bf16 v[4:7], v[228:231], v[192:195], v[4:7]
  ds_read_b64_tr_b16 v[210:211], v242 offset:17408
  v_mfma_f32_16x16x32_bf16 v[8:11], v[232:235], v[192:195], v[8:11]
  ds_read_b64_tr_b16 v[212:213], v243 offset:16384
  v_mfma_f32_16x16x32_bf16 v[12:15], v[236:239], v[192:195], v[12:15]
  ds_read_b64_tr_b16 v[214:215], v243 offset:17408
  v_mfma_f32_16x16x32_bf16 v[16:19], v[224:227], v[196:199], v[16:19]
  ds_read_b64_tr_b16 v[216:217], v244 offset:16384
  ds_read_b128 v[192:195], v240 offset:16384
  v_mfma_f32_16x16x32_bf16 v[20:23], v[228:231], v[196:199], v[20:23]
  ds_read_b64_tr_b16 v[218:219], v244 offset:17408
  v_mfma_f32_16x16x32_bf16 v[24:27], v[232:235], v[196:199], v[24:27]
  ds_read_b64_tr_b16 v[220:221], v245 offset:16384
  v_mfma_f32_16x16x32_bf16 v[28:31], v[236:239], v[196:199], v[28:31]
  ds_read_b64_tr_b16 v[222:223], v245 offset:17408
  v_mfma_f32_16x16x32_bf16 v[32:35], v[224:227], v[200:203], v[32:35]
  ds_read_b128 v[204:207], v240 offset:22528
  ds_read_b128 v[196:199], v240 offset:18432
  v_mfma_f32_16x16x32_bf16 v[36:39], v[228:231], v[200:203], v[36:39]
  v_mfma_f32_16x16x32_bf16 v[40:43], v[232:235], v[200:203], v[40:43]
  v_mfma_f32_16x16x32_bf16 v[44:47], v[236:239], v[200:203], v[44:47]
  v_mfma_f32_16x16x32_bf16 v[48:51], v[224:227], v[246:249], v[48:51]
  ds_read_b128 v[200:203], v240 offset:20480
  v_mfma_f32_16x16x32_bf16 v[52:55], v[228:231], v[246:249], v[52:55]
  v_mfma_f32_16x16x32_bf16 v[56:59], v[232:235], v[246:249], v[56:59]
  v_mfma_f32_16x16x32_bf16 v[60:63], v[236:239], v[246:249], v[60:63]
  s_waitcnt lgkmcnt(6)
  v_mfma_f32_16x16x32_bf16 v[0:3], v[208:211], v[192:195], v[0:3]
  ds_read_b64_tr_b16 v[224:225], v242 offset:24576
  v_mfma_f32_16x16x32_bf16 v[4:7], v[212:215], v[192:195], v[4:7]
  ds_read_b64_tr_b16 v[226:227], v242 offset:25600
  s_waitcnt lgkmcnt(3)
  v_mfma_f32_16x16x32_bf16 v[8:11], v[216:219], v[192:195], v[8:11]
  ds_read_b64_tr_b16 v[228:229], v243 offset:24576
  v_mfma_f32_16x16x32_bf16 v[12:15], v[220:223], v[192:195], v[12:15]
  ds_read_b64_tr_b16 v[230:231], v243 offset:25600
  v_mfma_f32_16x16x32_bf16 v[16:19], v[208:211], v[196:199], v[16:19]
  ds_read_b64_tr_b16 v[232:233], v244 offset:24576
  ds_read_b128 v[192:195], v241 offset:16384
  v_mfma_f32_16x16x32_bf16 v[20:23], v[212:215], v[196:199], v[20:23]
  ds_read_b64_tr_b16 v[234:235], v244 offset:25600
  v_mfma_f32_16x16x32_bf16 v[24:27], v[216:219], v[196:199], v[24:27]
  ds_read_b64_tr_b16 v[236:237], v245 offset:24576
  v_mfma_f32_16x16x32_bf16 v[28:31], v[220:223], v[196:199], v[28:31]
  ds_read_b64_tr_b16 v[238:239], v245 offset:25600
  s_waitcnt lgkmcnt(9)
  v_mfma_f32_16x16x32_bf16 v[32:35], v[208:211], v[200:203], v[32:35]
  ds_read_b128 v[246:249], v241 offset:22528
  ds_read_b128 v[196:199], v241 offset:18432
  v_mfma_f32_16x16x32_bf16 v[36:39], v[212:215], v[200:203], v[36:39]
  v_mfma_f32_16x16x32_bf16 v[40:43], v[216:219], v[200:203], v[40:43]
  v_mfma_f32_16x16x32_bf16 v[44:47], v[220:223], v[200:203], v[44:47]
  v_mfma_f32_16x16x32_bf16 v[48:51], v[208:211], v[204:207], v[48:51]
  ds_read_b128 v[200:203], v241 offset:20480
  v_mfma_f32_16x16x32_bf16 v[52:55], v[212:215], v[204:207], v[52:55]
  v_mfma_f32_16x16x32_bf16 v[56:59], v[216:219], v[204:207], v[56:59]
  v_mfma_f32_16x16x32_bf16 v[60:63], v[220:223], v[204:207], v[60:63]
  s_waitcnt lgkmcnt(0)
  v_mfma_f32_16x16x32_bf16 v[0:3], v[224:227], v[192:195], v[0:3]
  s_barrier
  ds_read_b64_tr_b16 v[208:209], v242 offset:32768
  v_mfma_f32_16x16x32_bf16 v[4:7], v[228:231], v[192:195], v[4:7]
  ds_read_b64_tr_b16 v[210:211], v242 offset:33792
  v_mfma_f32_16x16x32_bf16 v[8:11], v[232:235], v[192:195], v[8:11]
  ds_read_b64_tr_b16 v[212:213], v243 offset:32768
  v_mfma_f32_16x16x32_bf16 v[12:15], v[236:239], v[192:195], v[12:15]
  ds_read_b64_tr_b16 v[214:215], v243 offset:33792
  v_mfma_f32_16x16x32_bf16 v[16:19], v[224:227], v[196:199], v[16:19]
  ds_read_b64_tr_b16 v[216:217], v244 offset:32768
  ds_read_b128 v[192:195], v240 offset:32768
  v_mfma_f32_16x16x32_bf16 v[20:23], v[228:231], v[196:199], v[20:23]
  ds_read_b64_tr_b16 v[218:219], v244 offset:33792
  v_mfma_f32_16x16x32_bf16 v[24:27], v[232:235], v[196:199], v[24:27]
  ds_read_b64_tr_b16 v[220:221], v245 offset:32768
  v_mfma_f32_16x16x32_bf16 v[28:31], v[236:239], v[196:199], v[28:31]
  ds_read_b64_tr_b16 v[222:223], v245 offset:33792
  v_mfma_f32_16x16x32_bf16 v[32:35], v[224:227], v[200:203], v[32:35]
  ds_read_b128 v[204:207], v240 offset:38912
  ds_read_b128 v[196:199], v240 offset:34816
  v_mfma_f32_16x16x32_bf16 v[36:39], v[228:231], v[200:203], v[36:39]
  v_mfma_f32_16x16x32_bf16 v[40:43], v[232:235], v[200:203], v[40:43]
  v_mfma_f32_16x16x32_bf16 v[44:47], v[236:239], v[200:203], v[44:47]
  v_mfma_f32_16x16x32_bf16 v[48:51], v[224:227], v[246:249], v[48:51]
  ds_read_b128 v[200:203], v240 offset:36864
  v_mfma_f32_16x16x32_bf16 v[52:55], v[228:231], v[246:249], v[52:55]
  v_mfma_f32_16x16x32_bf16 v[56:59], v[232:235], v[246:249], v[56:59]
  v_mfma_f32_16x16x32_bf16 v[60:63], v[236:239], v[246:249], v[60:63]
  s_waitcnt lgkmcnt(6)
  v_mfma_f32_16x16x32_bf16 v[0:3], v[208:211], v[192:195], v[0:3]
  ds_read_b64_tr_b16 v[224:225], v242 offset:40960
  v_mfma_f32_16x16x32_bf16 v[4:7], v[212:215], v[192:195], v[4:7]
  ds_read_b64_tr_b16 v[226:227], v242 offset:41984
  s_waitcnt lgkmcnt(3)
  v_mfma_f32_16x16x32_bf16 v[8:11], v[216:219], v[192:195], v[8:11]
  ds_read_b64_tr_b16 v[228:229], v243 offset:40960
  v_mfma_f32_16x16x32_bf16 v[12:15], v[220:223], v[192:195], v[12:15]
  ds_read_b64_tr_b16 v[230:231], v243 offset:41984
  v_mfma_f32_16x16x32_bf16 v[16:19], v[208:211], v[196:199], v[16:19]
  ds_read_b64_tr_b16 v[232:233], v244 offset:40960
  ds_read_b128 v[192:195], v241 offset:32768
  v_mfma_f32_16x16x32_bf16 v[20:23], v[212:215], v[196:199], v[20:23]
  ds_read_b64_tr_b16 v[234:235], v244 offset:41984
  v_mfma_f32_16x16x32_bf16 v[24:27], v[216:219], v[196:199], v[24:27]
  ds_read_b64_tr_b16 v[236:237], v245 offset:40960
  v_mfma_f32_16x16x32_bf16 v[28:31], v[220:223], v[196:199], v[28:31]
  ds_read_b64_tr_b16 v[238:239], v245 offset:41984
  s_waitcnt lgkmcnt(9)
  v_mfma_f32_16x16x32_bf16 v[32:35], v[208:211], v[200:203], v[32:35]
  ds_read_b128 v[246:249], v241 offset:38912
  ds_read_b128 v[196:199], v241 offset:34816
  v_mfma_f32_16x16x32_bf16 v[36:39], v[212:215], v[200:203], v[36:39]
  v_mfma_f32_16x16x32_bf16 v[40:43], v[216:219], v[200:203], v[40:43]
  v_mfma_f32_16x16x32_bf16 v[44:47], v[220:223], v[200:203], v[44:47]
  v_mfma_f32_16x16x32_bf16 v[48:51], v[208:211], v[204:207], v[48:51]
  ds_read_b128 v[200:203], v241 offset:36864
  v_mfma_f32_16x16x32_bf16 v[52:55], v[212:215], v[204:207], v[52:55]
  v_mfma_f32_16x16x32_bf16 v[56:59], v[216:219], v[204:207], v[56:59]
  v_mfma_f32_16x16x32_bf16 v[60:63], v[220:223], v[204:207], v[60:63]
  s_cmp_eq_u32 s50, 3
  s_cbranch_scc1 L_tail
  s_waitcnt lgkmcnt(0)
  v_mfma_f32_16x16x32_bf16 v[0:3], v[224:227], v[192:195], v[0:3]
  s_barrier
  ds_read_b64_tr_b16 v[208:209], v242 offset:49152
  v_mfma_f32_16x16x32_bf16 v[4:7], v[228:231], v[192:195], v[4:7]
  ds_read_b64_tr_b16 v[210:211], v242 offset:50176
  v_mfma_f32_16x16x32_bf16 v[8:11], v[232:235], v[192:195], v[8:11]
  ds_read_b64_tr_b16 v[212:213], v243 offset:49152
  v_mfma_f32_16x16x32_bf16 v[12:15], v[236:239], v[192:195], v[12:15]
  ds_read_b64_tr_b16 v[214:215], v243 offset:50176
  v_mfma_f32_16x16x32_bf16 v[16:19], v[224:227], v[196:199], v[16:19]
  ds_read_b64_tr_b16 v[216:217], v244 offset:49152
  ds_read_b128 v[192:195], v240 offset:49152
  v_mfma_f32_16x16x32_bf16 v[20:23], v[228:231], v[196:199], v[20:23]
  ds_read_b64_tr_b16 v[218:219], v244 offset:50176
  v_mfma_f32_16x16x32_bf16 v[24:27], v[232:235], v[196:199], v[24:27]
  ds_read_b64_tr_b16 v[220:221], v245 offset:49152
  v_mfma_f32_16x16x32_bf16 v[28:31], v[236:239], v[196:199], v[28:31]
  ds_read_b64_tr_b16 v[222:223], v245 offset:50176
  v_mfma_f32_16x16x32_bf16 v[32:35], v[224:227], v[200:203], v[32:35]
  ds_read_b128 v[204:207], v240 offset:55296
  ds_read_b128 v[196:199], v240 offset:51200
  v_mfma_f32_16x16x32_bf16 v[36:39], v[228:231], v[200:203], v[36:39]
  v_mfma_f32_16x16x32_bf16 v[40:43], v[232:235], v[200:203], v[40:43]
  v_mfma_f32_16x16x32_bf16 v[44:47], v[236:239], v[200:203], v[44:47]
  v_mfma_f32_16x16x32_bf16 v[48:51], v[224:227], v[246:249], v[48:51]
  ds_read_b128 v[200:203], v240 offset:53248
  v_mfma_f32_16x16x32_bf16 v[52:55], v[228:231], v[246:249], v[52:55]
  v_mfma_f32_16x16x32_bf16 v[56:59], v[232:235], v[246:249], v[56:59]
  v_mfma_f32_16x16x32_bf16 v[60:63], v[236:239], v[246:249], v[60:63]
  s_waitcnt lgkmcnt(6)
  v_mfma_f32_16x16x32_bf16 v[0:3], v[208:211], v[192:195], v[0:3]
  ds_read_b64_tr_b16 v[224:225], v242 offset:57344
  v_mfma_f32_16x16x32_bf16 v[4:7], v[212:215], v[192:195], v[4:7]
  ds_read_b64_tr_b16 v[226:227], v242 offset:58368
  s_waitcnt lgkmcnt(3)
  v_mfma_f32_16x16x32_bf16 v[8:11], v[216:219], v[192:195], v[8:11]
  ds_read_b64_tr_b16 v[228:229], v243 offset:57344
  v_mfma_f32_16x16x32_bf16 v[12:15], v[220:223], v[192:195], v[12:15]
  ds_read_b64_tr_b16 v[230:231], v243 offset:58368
  v_mfma_f32_16x16x32_bf16 v[16:19], v[208:211], v[196:199], v[16:19]
  ds_read_b64_tr_b16 v[232:233], v244 offset:57344
  ds_read_b128 v[192:195], v241 offset:49152
  v_mfma_f32_16x16x32_bf16 v[20:23], v[212:215], v[196:199], v[20:23]
  ds_read_b64_tr_b16 v[234:235], v244 offset:58368
  v_mfma_f32_16x16x32_bf16 v[24:27], v[216:219], v[196:199], v[24:27]
  ds_read_b64_tr_b16 v[236:237], v245 offset:57344
  v_mfma_f32_16x16x32_bf16 v[28:31], v[220:223], v[196:199], v[28:31]
  ds_read_b64_tr_b16 v[238:239], v245 offset:58368
  s_waitcnt lgkmcnt(9)
  v_mfma_f32_16x16x32_bf16 v[32:35], v[208:211], v[200:203], v[32:35]
  ds_read_b128 v[246:249], v241 offset:55296
  ds_read_b128 v[196:199], v241 offset:51200
  v_mfma_f32_16x16x32_bf16 v[36:39], v[212:215], v[200:203], v[36:39]
  v_mfma_f32_16x16x32_bf16 v[40:43], v[216:219], v[200:203], v[40:43]
  v_mfma_f32_16x16x32_bf16 v[44:47], v[220:223], v[200:203], v[44:47]
  v_mfma_f32_16x16x32_bf16 v[48:51], v[208:211], v[204:207], v[48:51]
  ds_read_b128 v[200:203], v241 offset:53248
  v_mfma_f32_16x16x32_bf16 v[52:55], v[212:215], v[204:207], v[52:55]
  v_mfma_f32_16x16x32_bf16 v[56:59], v[216:219], v[204:207], v[56:59]
  v_mfma_f32_16x16x32_bf16 v[60:63], v[220:223], v[204:207], v[60:63]
  s_waitcnt lgkmcnt(0)
  v_mfma_f32_16x16x32_bf16 v[0:3], v[224:227], v[192:195], v[0:3]
  s_barrier
  ds_read_b64_tr_b16 v[208:209], v242 offset:0
  v_mfma_f32_16x16x32_bf16 v[4:7], v[228:231], v[192:195], v[4:7]
  ds_read_b64_tr_b16 v[210:211], v242 offset:1024
  v_mfma_f32_16x16x32_bf16 v[8:11], v[232:235], v[192:195], v[8:11]
  ds_read_b64_tr_b16 v[212:213], v243 offset:0
  v_mfma_f32_16x16x32_bf16 v[12:15], v[236:239], v[192:195], v[12:15]
  ds_read_b64_tr_b16 v[214:215], v243 offset:1024
  v_mfma_f32_16x16x32_bf16 v[16:19], v[224:227], v[196:199], v[16:19]
  ds_read_b64_tr_b16 v[216:217], v244 offset:0
  ds_read_b128 v[192:195], v240 offset:0
  v_mfma_f32_16x16x32_bf16 v[20:23], v[228:231], v[196:199], v[20:23]
  ds_read_b64_tr_b16 v[218:219], v244 offset:1024
  v_mfma_f32_16x16x32_bf16 v[24:27], v[232:235], v[196:199], v[24:27]
  ds_read_b64_tr_b16 v[220:221], v245 offset:0
  v_mfma_f32_16x16x32_bf16 v[28:31], v[236:239], v[196:199], v[28:31]
  ds_read_b64_tr_b16 v[222:223], v245 offset:1024
  v_mfma_f32_16x16x32_bf16 v[32:35], v[224:227], v[200:203], v[32:35]
  ds_read_b128 v[204:207], v240 offset:6144
  ds_read_b128 v[196:199], v240 offset:2048
  v_mfma_f32_16x16x32_bf16 v[36:39], v[228:231], v[200:203], v[36:39]
  v_mfma_f32_16x16x32_bf16 v[40:43], v[232:235], v[200:203], v[40:43]
  v_mfma_f32_16x16x32_bf16 v[44:47], v[236:239], v[200:203], v[44:47]
  v_mfma_f32_16x16x32_bf16 v[48:51], v[224:227], v[246:249], v[48:51]
  ds_read_b128 v[200:203], v240 offset:4096
  v_mfma_f32_16x16x32_bf16 v[52:55], v[228:231], v[246:249], v[52:55]
  v_mfma_f32_16x16x32_bf16 v[56:59], v[232:235], v[246:249], v[56:59]
  v_mfma_f32_16x16x32_bf16 v[60:63], v[236:239], v[246:249], v[60:63]
  s_add_u32 s50, s50, 1
  s_branch L_iter
L_tail:
  s_add_u32 s52, s49, 1
  s_and_b32 s47, s49, 1
  s_cmp_eq_u32 s55, 0
  s_cselect_b32 s46, s49, s47
  s_lshl_b32 s46, s46, 23
  s_lshl_b32 s47, s41, 18
  s_add_u32 s46, s46, s47
  s_lshl_b32 s47, s42, 15
  s_add_u32 s46, s46, s47
  s_lshl_b32 s47, s44, 14
  s_add_u32 s46, s46, s47
  v_add_u32 v254, s47, v250
  s_lshl_b32 s47, s45, 13
  s_add_u32 s46, s46, s47
  v_add_u32 v254, s47, v254
  s_add_u32 s53, s46, 4096
  v_add_u32 v251, 512, v251
  s_waitcnt lgkmcnt(0)
  v_mfma_f32_16x16x32_bf16 v[0:3], v[224:227], v[192:195], v[0:3]
  s_barrier
  ds_read_b64_tr_b16 v[208:209], v242 offset:49152
  v_mfma_f32_16x16x32_bf16 v[4:7], v[228:231], v[192:195], v[4:7]
  ds_read_b64_tr_b16 v[210:211], v242 offset:50176
  v_mfma_f32_16x16x32_bf16 v[8:11], v[232:235], v[192:195], v[8:11]
  ds_read_b64_tr_b16 v[212:213], v243 offset:49152
  v_mfma_f32_16x16x32_bf16 v[12:15], v[236:239], v[192:195], v[12:15]
  ds_read_b64_tr_b16 v[214:215], v243 offset:50176
  v_mfma_f32_16x16x32_bf16 v[16:19], v[224:227], v[196:199], v[16:19]
  ds_read_b64_tr_b16 v[216:217], v244 offset:49152
  ds_read_b128 v[192:195], v240 offset:49152
  v_mfma_f32_16x16x32_bf16 v[20:23], v[228:231], v[196:199], v[20:23]
  ds_read_b64_tr_b16 v[218:219], v244 offset:50176
  v_mfma_f32_16x16x32_bf16 v[24:27], v[232:235], v[196:199], v[24:27]
  ds_read_b64_tr_b16 v[220:221], v245 offset:49152
  v_mfma_f32_16x16x32_bf16 v[28:31], v[236:239], v[196:199], v[28:31]
  ds_read_b64_tr_b16 v[222:223], v245 offset:50176
  v_mfma_f32_16x16x32_bf16 v[32:35], v[224:227], v[200:203], v[32:35]
  ds_read_b128 v[204:207], v240 offset:53248
  ds_read_b128 v[196:199], v240 offset:51200
  v_mfma_f32_16x16x32_bf16 v[36:39], v[228:231], v[200:203], v[36:39]
  v_mfma_f32_16x16x32_bf16 v[40:43], v[232:235], v[200:203], v[40:43]
  v_mfma_f32_16x16x32_bf16 v[44:47], v[236:239], v[200:203], v[44:47]
  v_mfma_f32_16x16x32_bf16 v[48:51], v[224:227], v[246:249], v[48:51]
  ds_read_b128 v[200:203], v241 offset:49152
  v_mfma_f32_16x16x32_bf16 v[52:55], v[228:231], v[246:249], v[52:55]
  v_mfma_f32_16x16x32_bf16 v[56:59], v[232:235], v[246:249], v[56:59]
  v_mfma_f32_16x16x32_bf16 v[60:63], v[236:239], v[246:249], v[60:63]
  s_cmp_eq_u32 s57, 3
  s_cbranch_scc1 L_x0rdT
L_x0retT:
  s_cmp_eq_u32 s52, 6
  s_cbranch_scc1 L_final
  s_cmp_eq_u32 s55, 0
  s_cbranch_scc1 L_tailslow
  s_waitcnt lgkmcnt(6)
  v_mfma_f32_16x16x32_bf16 v[0:3], v[208:211], v[192:195], v[0:3]
  ds_read_b64_tr_b16 v[224:225], v242 offset:57344
  ds_read_b64_tr_b16 v[226:227], v242 offset:58368
  v_mfma_f32_16x16x32_bf16 v[4:7], v[212:215], v[192:195], v[4:7]
  ds_read_b64_tr_b16 v[228:229], v243 offset:57344
  ds_read_b64_tr_b16 v[230:231], v243 offset:58368
  s_waitcnt lgkmcnt(9)
  v_mfma_f32_16x16x32_bf16 v[8:11], v[216:219], v[192:195], v[8:11]
  ds_read_b64_tr_b16 v[232:233], v244 offset:57344
  ds_read_b64_tr_b16 v[234:235], v244 offset:58368
  s_waitcnt lgkmcnt(9)
  v_mfma_f32_16x16x32_bf16 v[12:15], v[220:223], v[192:195], v[12:15]
  ds_read_b64_tr_b16 v[236:237], v245 offset:57344
  ds_read_b64_tr_b16 v[238:239], v245 offset:58368
  s_waitcnt lgkmcnt(9)
  v_mfma_f32_16x16x32_bf16 v[16:19], v[208:211], v[196:199], v[16:19]
  ds_read_b128 v[192:195], v241 offset:51200
  v_mfma_f32_16x16x32_bf16 v[20:23], v[212:215], v[196:199], v[20:23]
  v_mfma_f32_16x16x32_bf16 v[24:27], v[216:219], v[196:199], v[24:27]
  v_mfma_f32_16x16x32_bf16 v[28:31], v[220:223], v[196:199], v[28:31]
  s_waitcnt lgkmcnt(7)
  v_mfma_f32_16x16x32_bf16 v[0:3], v[224:227], v[200:203], v[0:3]
  ds_read_b128 v[196:199], v240 offset:55296
  s_waitcnt lgkmcnt(6)
  v_mfma_f32_16x16x32_bf16 v[4:7], v[228:231], v[200:203], v[4:7]
  s_waitcnt lgkmcnt(4)
  v_mfma_f32_16x16x32_bf16 v[8:11], v[232:235], v[200:203], v[8:11]
  s_waitcnt lgkmcnt(2)
  v_mfma_f32_16x16x32_bf16 v[12:15], v[236:239], v[200:203], v[12:15]
  v_mfma_f32_16x16x32_bf16 v[32:35], v[208:211], v[204:207], v[32:35]
  ds_read_b128 v[200:203], v241 offset:53248
  v_fma_f32 v128, v64, v0, v128
  v_fma_f32 v129, v65, v1, v129
  v_fma_f32 v130, v66, v2, v130
  v_fma_f32 v131, v67, v3, v131
  v_mfma_f32_16x16x32_bf16 v[36:39], v[212:215], v[204:207], v[36:39]
  v_fma_f32 v132, v68, v4, v132
  v_fma_f32 v133, v69, v5, v133
  v_fma_f32 v134, v70, v6, v134
  v_fma_f32 v135, v71, v7, v135
  v_mfma_f32_16x16x32_bf16 v[40:43], v[216:219], v[204:207], v[40:43]
  v_cvt_pk_bf16_f32 v0, v128, v129
  v_cvt_pk_bf16_f32 v1, v130, v131
  v_cvt_pk_bf16_f32 v2, v132, v133
  v_cvt_pk_bf16_f32 v3, v134, v135
  buffer_store_dwordx4 v[0:3], v250, s[24:27], s46 offen offset:0
  v_mfma_f32_16x16x32_bf16 v[44:47], v[220:223], v[204:207], v[44:47]
  v_fma_f32 v136, v72, v8, v136
  v_fma_f32 v137, v73, v9, v137
  v_fma_f32 v138, v74, v10, v138
  v_fma_f32 v139, v75, v11, v139
  s_waitcnt lgkmcnt(2)
  v_mfma_f32_16x16x32_bf16 v[16:19], v[224:227], v[192:195], v[16:19]
  ds_read_b128 v[204:207], v241 offset:55296
  v_fma_f32 v140, v76, v12, v140
  v_fma_f32 v141, v77, v13, v141
  v_fma_f32 v142, v78, v14, v142
  v_fma_f32 v143, v79, v15, v143
  v_mfma_f32_16x16x32_bf16 v[20:23], v[228:231], v[192:195], v[20:23]
  v_cvt_pk_bf16_f32 v8, v136, v137
  v_cvt_pk_bf16_f32 v9, v138, v139
  v_cvt_pk_bf16_f32 v10, v140, v141
  v_cvt_pk_bf16_f32 v11, v142, v143
  buffer_store_dwordx4 v[8:11], v250, s[24:27], s46 offen offset:1024
  v_mfma_f32_16x16x32_bf16 v[24:27], v[232:235], v[192:195], v[24:27]
  v_mfma_f32_16x16x32_bf16 v[28:31], v[236:239], v[192:195], v[28:31]
  s_waitcnt lgkmcnt(2)
  v_mfma_f32_16x16x32_bf16 v[48:51], v[208:211], v[196:199], v[48:51]
  v_fma_f32 v144, v80, v16, v144
  v_fma_f32 v145, v81, v17, v145
  v_fma_f32 v146, v82, v18, v146
  v_fma_f32 v147, v83, v19, v147
  v_mfma_f32_16x16x32_bf16 v[52:55], v[212:215], v[196:199], v[52:55]
  v_fma_f32 v148, v84, v20, v148
  v_fma_f32 v149, v85, v21, v149
  v_fma_f32 v150, v86, v22, v150
  v_fma_f32 v151, v87, v23, v151
  v_mfma_f32_16x16x32_bf16 v[56:59], v[216:219], v[196:199], v[56:59]
  v_cvt_pk_bf16_f32 v16, v144, v145
  v_cvt_pk_bf16_f32 v17, v146, v147
  v_cvt_pk_bf16_f32 v18, v148, v149
  v_cvt_pk_bf16_f32 v19, v150, v151
  buffer_store_dwordx4 v[16:19], v250, s[24:27], s46 offen offset:2048
  v_mfma_f32_16x16x32_bf16 v[60:63], v[220:223], v[196:199], v[60:63]
  s_waitcnt lgkmcnt(0)
  s_barrier
  v_fma_f32 v152, v88, v24, v152
  v_fma_f32 v153, v89, v25, v153
  v_fma_f32 v154, v90, v26, v154
  v_fma_f32 v155, v91, v27, v155
  v_mfma_f32_16x16x32_bf16 v[32:35], v[224:227], v[200:203], v[32:35]
  ds_read_b64_tr_b16 v[208:209], v242 offset:0
  ds_read_b64_tr_b16 v[210:211], v242 offset:1024
  v_fma_f32 v156, v92, v28, v156
  v_fma_f32 v157, v93, v29, v157
  v_fma_f32 v158, v94, v30, v158
  v_fma_f32 v159, v95, v31, v159
  v_mfma_f32_16x16x32_bf16 v[36:39], v[228:231], v[200:203], v[36:39]
  ds_read_b64_tr_b16 v[212:213], v243 offset:0
  ds_read_b64_tr_b16 v[214:215], v243 offset:1024
  v_cvt_pk_bf16_f32 v24, v152, v153
  v_cvt_pk_bf16_f32 v25, v154, v155
  v_cvt_pk_bf16_f32 v26, v156, v157
  v_cvt_pk_bf16_f32 v27, v158, v159
  buffer_store_dwordx4 v[24:27], v250, s[24:27], s46 offen offset:3072
  v_mfma_f32_16x16x32_bf16 v[40:43], v[232:235], v[200:203], v[40:43]
  ds_read_b64_tr_b16 v[216:217], v244 offset:0
  ds_read_b64_tr_b16 v[218:219], v244 offset:1024
  v_mfma_f32_16x16x32_bf16 v[44:47], v[236:239], v[200:203], v[44:47]
  ds_read_b64_tr_b16 v[220:221], v245 offset:0
  ds_read_b64_tr_b16 v[222:223], v245 offset:1024
  v_mfma_f32_16x16x32_bf16 v[48:51], v[224:227], v[204:207], v[48:51]
  v_fma_f32 v160, v96, v32, v160
  v_fma_f32 v161, v97, v33, v161
  v_fma_f32 v162, v98, v34, v162
  v_fma_f32 v163, v99, v35, v163
  v_mfma_f32_16x16x32_bf16 v[52:55], v[228:231], v[204:207], v[52:55]
  v_fma_f32 v164, v100, v36, v164
  v_fma_f32 v165, v101, v37, v165
  v_fma_f32 v166, v102, v38, v166
  v_fma_f32 v167, v103, v39, v167
  v_mfma_f32_16x16x32_bf16 v[56:59], v[232:235], v[204:207], v[56:59]
  v_cvt_pk_bf16_f32 v32, v160, v161
  v_cvt_pk_bf16_f32 v33, v162, v163
  v_cvt_pk_bf16_f32 v34, v164, v165
  v_cvt_pk_bf16_f32 v35, v166, v167
  buffer_store_dwordx4 v[32:35], v250, s[24:27], s53 offen offset:0
  v_mfma_f32_16x16x32_bf16 v[60:63], v[236:239], v[204:207], v[60:63]
  v_fma_f32 v168, v104, v40, v168
  v_fma_f32 v169, v105, v41, v169
  v_fma_f32 v170, v106, v42, v170
  v_fma_f32 v171, v107, v43, v171
  v_pk_fma_f32 v[172:173], v[108:109], v[44:45], v[172:173]
  v_pk_fma_f32 v[174:175], v[110:111], v[46:47], v[174:175]
  v_cvt_pk_bf16_f32 v40, v168, v169
  v_cvt_pk_bf16_f32 v41, v170, v171
  v_cvt_pk_bf16_f32 v42, v172, v173
  v_cvt_pk_bf16_f32 v43, v174, v175
  buffer_store_dwordx4 v[40:43], v250, s[24:27], s53 offen offset:1024
  v_pk_fma_f32 v[176:177], v[112:113], v[48:49], v[176:177]
  v_pk_fma_f32 v[178:179], v[114:115], v[50:51], v[178:179]
  v_pk_fma_f32 v[180:181], v[116:117], v[52:53], v[180:181]
  v_pk_fma_f32 v[182:183], v[118:119], v[54:55], v[182:183]
  v_cvt_pk_bf16_f32 v48, v176, v177
  v_cvt_pk_bf16_f32 v49, v178, v179
  v_cvt_pk_bf16_f32 v50, v180, v181
  v_cvt_pk_bf16_f32 v51, v182, v183
  buffer_store_dwordx4 v[48:51], v250, s[24:27], s53 offen offset:2048
  v_pk_fma_f32 v[184:185], v[120:121], v[56:57], v[184:185]
  v_pk_fma_f32 v[186:187], v[122:123], v[58:59], v[186:187]
  v_pk_fma_f32 v[188:189], v[124:125], v[60:61], v[188:189]
  v_pk_fma_f32 v[190:191], v[126:127], v[62:63], v[190:191]
  v_cvt_pk_bf16_f32 v56, v184, v185
  v_cvt_pk_bf16_f32 v57, v186, v187
  v_cvt_pk_bf16_f32 v58, v188, v189
  v_cvt_pk_bf16_f32 v59, v190, v191
  buffer_store_dwordx4 v[56:59], v250, s[24:27], s53 offen offset:3072
  ds_write_b128 v254, v[0:3] offset:0
  ds_read_b128 v[0:3], v251 offset:0
  ds_read_b128 v[4:7], v251 offset:64
  ds_write_b128 v254, v[8:11] offset:1024
  ds_read_b128 v[8:11], v251 offset:128
  ds_read_b128 v[12:15], v251 offset:192
  ds_write_b128 v254, v[16:19] offset:2048
  ds_read_b128 v[16:19], v251 offset:0
  ds_read_b128 v[20:23], v251 offset:64
  ds_write_b128 v254, v[24:27] offset:3072
  ds_read_b128 v[24:27], v251 offset:128
  ds_read_b128 v[28:31], v251 offset:192
  ds_write_b128 v254, v[32:35] offset:4096
  ds_read_b128 v[32:35], v251 offset:0
  ds_read_b128 v[36:39], v251 offset:64
  ds_write_b128 v254, v[40:43] offset:5120
  ds_read_b128 v[40:43], v251 offset:128
  ds_read_b128 v[44:47], v251 offset:192
  ds_write_b128 v254, v[48:51] offset:6144
  ds_read_b128 v[48:51], v251 offset:0
  ds_read_b128 v[52:55], v251 offset:64
  ds_write_b128 v254, v[56:59] offset:7168
  ds_read_b128 v[56:59], v251 offset:128
  ds_read_b128 v[60:63], v251 offset:192
  s_lshl_b32 s47, s45, 13
  v_add_u32 v240, s47, v250
  v_add_u32 v241, 1024, v240
  s_waitcnt vmcnt(0)
  v_mov_b32 v254, s52
  v_mov_b32 v255, 0
  s_mov_b64 exec, 1
  buffer_store_dword v254, v255, s[24:27], s51 offen
  s_mov_b64 exec, -1
  s_waitcnt lgkmcnt(0)
  s_barrier
  ds_read_b128 v[192:195], v240 offset:0
  ds_read_b128 v[196:199], v240 offset:2048
  ds_read_b128 v[200:203], v240 offset:4096
  ds_read_b128 v[204:207], v240 offset:6144
  s_mov_b32 s49, s52
  s_mov_b32 s58, 1
  s_mov_b32 s59, 0
  s_mov_b32 s57, 100
  s_waitcnt lgkmcnt(0)
  s_branch L_layer
L_tailslow:
  s_waitcnt lgkmcnt(6)
  v_mfma_f32_16x16x32_bf16 v[0:3], v[208:211], v[192:195], v[0:3]
  ds_read_b64_tr_b16 v[224:225], v242 offset:57344
  ds_read_b64_tr_b16 v[226:227], v242 offset:58368
  v_mfma_f32_16x16x32_bf16 v[4:7], v[212:215], v[192:195], v[4:7]
  ds_read_b64_tr_b16 v[228:229], v243 offset:57344
  ds_read_b64_tr_b16 v[230:231], v243 offset:58368
  s_waitcnt lgkmcnt(9)
  v_mfma_f32_16x16x32_bf16 v[8:11], v[216:219], v[192:195], v[8:11]
  ds_read_b64_tr_b16 v[232:233], v244 offset:57344
  ds_read_b64_tr_b16 v[234:235], v244 offset:58368
  s_waitcnt lgkmcnt(9)
  v_mfma_f32_16x16x32_bf16 v[12:15], v[220:223], v[192:195], v[12:15]
  ds_read_b64_tr_b16 v[236:237], v245 offset:57344
  ds_read_b64_tr_b16 v[238:239], v245 offset:58368
  s_waitcnt lgkmcnt(9)
  v_mfma_f32_16x16x32_bf16 v[16:19], v[208:211], v[196:199], v[16:19]
  ds_read_b128 v[192:195], v241 offset:51200
  v_mfma_f32_16x16x32_bf16 v[20:23], v[212:215], v[196:199], v[20:23]
  v_mfma_f32_16x16x32_bf16 v[24:27], v[216:219], v[196:199], v[24:27]
  v_mfma_f32_16x16x32_bf16 v[28:31], v[220:223], v[196:199], v[28:31]
  s_waitcnt lgkmcnt(7)
  v_mfma_f32_16x16x32_bf16 v[0:3], v[224:227], v[200:203], v[0:3]
  ds_read_b128 v[196:199], v240 offset:55296
  s_waitcnt lgkmcnt(6)
  v_mfma_f32_16x16x32_bf16 v[4:7], v[228:231], v[200:203], v[4:7]
  s_waitcnt lgkmcnt(4)
  v_mfma_f32_16x16x32_bf16 v[8:11], v[232:235], v[200:203], v[8:11]
  s_waitcnt lgkmcnt(2)
  v_mfma_f32_16x16x32_bf16 v[12:15], v[236:239], v[200:203], v[12:15]
  v_mfma_f32_16x16x32_bf16 v[32:35], v[208:211], v[204:207], v[32:35]
  ds_read_b128 v[200:203], v241 offset:53248
  v_fma_f32 v128, v64, v0, v128
  v_fma_f32 v129, v65, v1, v129
  v_fma_f32 v130, v66, v2, v130
  v_fma_f32 v131, v67, v3, v131
  v_mfma_f32_16x16x32_bf16 v[36:39], v[212:215], v[204:207], v[36:39]
  v_fma_f32 v132, v68, v4, v132
  v_fma_f32 v133, v69, v5, v133
  v_fma_f32 v134, v70, v6, v134
  v_fma_f32 v135, v71, v7, v135
  v_mfma_f32_16x16x32_bf16 v[40:43], v[216:219], v[204:207], v[40:43]
  v_cvt_pk_bf16_f32 v0, v128, v129
  v_cvt_pk_bf16_f32 v1, v130, v131
  v_cvt_pk_bf16_f32 v2, v132, v133
  v_cvt_pk_bf16_f32 v3, v134, v135
  buffer_store_dwordx4 v[0:3], v250, s[24:27], s46 offen offset:0 sc1
  v_mfma_f32_16x16x32_bf16 v[44:47], v[220:223], v[204:207], v[44:47]
  v_fma_f32 v136, v72, v8, v136
  v_fma_f32 v137, v73, v9, v137
  v_fma_f32 v138, v74, v10, v138
  v_fma_f32 v139, v75, v11, v139
  s_waitcnt lgkmcnt(2)
  v_mfma_f32_16x16x32_bf16 v[16:19], v[224:227], v[192:195], v[16:19]
  ds_read_b128 v[204:207], v241 offset:55296
  v_fma_f32 v140, v76, v12, v140
  v_fma_f32 v141, v77, v13, v141
  v_fma_f32 v142, v78, v14, v142
  v_fma_f32 v143, v79, v15, v143
  v_mfma_f32_16x16x32_bf16 v[20:23], v[228:231], v[192:195], v[20:23]
  v_cvt_pk_bf16_f32 v8, v136, v137
  v_cvt_pk_bf16_f32 v9, v138, v139
  v_cvt_pk_bf16_f32 v10, v140, v141
  v_cvt_pk_bf16_f32 v11, v142, v143
  buffer_store_dwordx4 v[8:11], v250, s[24:27], s46 offen offset:1024 sc1
  v_mfma_f32_16x16x32_bf16 v[24:27], v[232:235], v[192:195], v[24:27]
  v_mfma_f32_16x16x32_bf16 v[28:31], v[236:239], v[192:195], v[28:31]
  s_waitcnt lgkmcnt(2)
  v_mfma_f32_16x16x32_bf16 v[48:51], v[208:211], v[196:199], v[48:51]
  v_fma_f32 v144, v80, v16, v144
  v_fma_f32 v145, v81, v17, v145
  v_fma_f32 v146, v82, v18, v146
  v_fma_f32 v147, v83, v19, v147
  v_mfma_f32_16x16x32_bf16 v[52:55], v[212:215], v[196:199], v[52:55]
  v_fma_f32 v148, v84, v20, v148
  v_fma_f32 v149, v85, v21, v149
  v_fma_f32 v150, v86, v22, v150
  v_fma_f32 v151, v87, v23, v151
  v_mfma_f32_16x16x32_bf16 v[56:59], v[216:219], v[196:199], v[56:59]
  v_cvt_pk_bf16_f32 v16, v144, v145
  v_cvt_pk_bf16_f32 v17, v146, v147
  v_cvt_pk_bf16_f32 v18, v148, v149
  v_cvt_pk_bf16_f32 v19, v150, v151
  buffer_store_dwordx4 v[16:19], v250, s[24:27], s46 offen offset:2048 sc1
  v_mfma_f32_16x16x32_bf16 v[60:63], v[220:223], v[196:199], v[60:63]
  s_waitcnt lgkmcnt(0)
  s_barrier
  v_fma_f32 v152, v88, v24, v152
  v_fma_f32 v153, v89, v25, v153
  v_fma_f32 v154, v90, v26, v154
  v_fma_f32 v155, v91, v27, v155
  v_mfma_f32_16x16x32_bf16 v[32:35], v[224:227], v[200:203], v[32:35]
  ds_read_b64_tr_b16 v[208:209], v242 offset:0
  ds_read_b64_tr_b16 v[210:211], v242 offset:1024
  v_fma_f32 v156, v92, v28, v156
  v_fma_f32 v157, v93, v29, v157
  v_fma_f32 v158, v94, v30, v158
  v_fma_f32 v159, v95, v31, v159
  v_mfma_f32_16x16x32_bf16 v[36:39], v[228:231], v[200:203], v[36:39]
  ds_read_b64_tr_b16 v[212:213], v243 offset:0
  ds_read_b64_tr_b16 v[214:215], v243 offset:1024
  v_cvt_pk_bf16_f32 v24, v152, v153
  v_cvt_pk_bf16_f32 v25, v154, v155
  v_cvt_pk_bf16_f32 v26, v156, v157
  v_cvt_pk_bf16_f32 v27, v158, v159
  buffer_store_dwordx4 v[24:27], v250, s[24:27], s46 offen offset:3072 sc1
  v_mfma_f32_16x16x32_bf16 v[40:43], v[232:235], v[200:203], v[40:43]
  ds_read_b64_tr_b16 v[216:217], v244 offset:0
  ds_read_b64_tr_b16 v[218:219], v244 offset:1024
  v_mfma_f32_16x16x32_bf16 v[44:47], v[236:239], v[200:203], v[44:47]
  ds_read_b64_tr_b16 v[220:221], v245 offset:0
  ds_read_b64_tr_b16 v[222:223], v245 offset:1024
  v_mfma_f32_16x16x32_bf16 v[48:51], v[224:227], v[204:207], v[48:51]
  v_fma_f32 v160, v96, v32, v160
  v_fma_f32 v161, v97, v33, v161
  v_fma_f32 v162, v98, v34, v162
  v_fma_f32 v163, v99, v35, v163
  v_mfma_f32_16x16x32_bf16 v[52:55], v[228:231], v[204:207], v[52:55]
  v_fma_f32 v164, v100, v36, v164
  v_fma_f32 v165, v101, v37, v165
  v_fma_f32 v166, v102, v38, v166
  v_fma_f32 v167, v103, v39, v167
  v_mfma_f32_16x16x32_bf16 v[56:59], v[232:235], v[204:207], v[56:59]
  v_cvt_pk_bf16_f32 v32, v160, v161
  v_cvt_pk_bf16_f32 v33, v162, v163
  v_cvt_pk_bf16_f32 v34, v164, v165
  v_cvt_pk_bf16_f32 v35, v166, v167
  buffer_store_dwordx4 v[32:35], v250, s[24:27], s53 offen offset:0 sc1
  v_mfma_f32_16x16x32_bf16 v[60:63], v[236:239], v[204:207], v[60:63]
  v_fma_f32 v168, v104, v40, v168
  v_fma_f32 v169, v105, v41, v169
  v_fma_f32 v170, v106, v42, v170
  v_fma_f32 v171, v107, v43, v171
  v_pk_fma_f32 v[172:173], v[108:109], v[44:45], v[172:173]
  v_pk_fma_f32 v[174:175], v[110:111], v[46:47], v[174:175]
  v_cvt_pk_bf16_f32 v40, v168, v169
  v_cvt_pk_bf16_f32 v41, v170, v171
  v_cvt_pk_bf16_f32 v42, v172, v173
  v_cvt_pk_bf16_f32 v43, v174, v175
  buffer_store_dwordx4 v[40:43], v250, s[24:27], s53 offen offset:1024 sc1
  v_pk_fma_f32 v[176:177], v[112:113], v[48:49], v[176:177]
  v_pk_fma_f32 v[178:179], v[114:115], v[50:51], v[178:179]
  v_pk_fma_f32 v[180:181], v[116:117], v[52:53], v[180:181]
  v_pk_fma_f32 v[182:183], v[118:119], v[54:55], v[182:183]
  v_cvt_pk_bf16_f32 v48, v176, v177
  v_cvt_pk_bf16_f32 v49, v178, v179
  v_cvt_pk_bf16_f32 v50, v180, v181
  v_cvt_pk_bf16_f32 v51, v182, v183
  buffer_store_dwordx4 v[48:51], v250, s[24:27], s53 offen offset:2048 sc1
  v_pk_fma_f32 v[184:185], v[120:121], v[56:57], v[184:185]
  v_pk_fma_f32 v[186:187], v[122:123], v[58:59], v[186:187]
  v_pk_fma_f32 v[188:189], v[124:125], v[60:61], v[188:189]
  v_pk_fma_f32 v[190:191], v[126:127], v[62:63], v[190:191]
  v_cvt_pk_bf16_f32 v56, v184, v185
  v_cvt_pk_bf16_f32 v57, v186, v187
  v_cvt_pk_bf16_f32 v58, v188, v189
  v_cvt_pk_bf16_f32 v59, v190, v191
  buffer_store_dwordx4 v[56:59], v250, s[24:27], s53 offen offset:3072 sc1
  ds_write_b128 v254, v[0:3] offset:0
  ds_read_b128 v[0:3], v251 offset:0
  ds_read_b128 v[4:7], v251 offset:64
  ds_write_b128 v254, v[8:11] offset:1024
  ds_read_b128 v[8:11], v251 offset:128
  ds_read_b128 v[12:15], v251 offset:192
  ds_write_b128 v254, v[16:19] offset:2048
  ds_read_b128 v[16:19], v251 offset:0
  ds_read_b128 v[20:23], v251 offset:64
  ds_write_b128 v254, v[24:27] offset:3072
  ds_read_b128 v[24:27], v251 offset:128
  ds_read_b128 v[28:31], v251 offset:192
  ds_write_b128 v254, v[32:35] offset:4096
  ds_read_b128 v[32:35], v251 offset:0
  ds_read_b128 v[36:39], v251 offset:64
  ds_write_b128 v254, v[40:43] offset:5120
  ds_read_b128 v[40:43], v251 offset:128
  ds_read_b128 v[44:47], v251 offset:192
  ds_write_b128 v254, v[48:51] offset:6144
  ds_read_b128 v[48:51], v251 offset:0
  ds_read_b128 v[52:55], v251 offset:64
  ds_write_b128 v254, v[56:59] offset:7168
  ds_read_b128 v[56:59], v251 offset:128
  ds_read_b128 v[60:63], v251 offset:192
  s_lshl_b32 s47, s45, 13
  v_add_u32 v240, s47, v250
  v_add_u32 v241, 1024, v240
  s_waitcnt vmcnt(0)
  v_mov_b32 v254, s52
  v_mov_b32 v255, 0
  s_mov_b64 exec, 1
  buffer_store_dword v254, v255, s[24:27], s51 offen sc1
  s_mov_b64 exec, -1
  s_waitcnt lgkmcnt(0)
  s_barrier
  ds_read_b128 v[192:195], v240 offset:0
  ds_read_b128 v[196:199], v240 offset:2048
  ds_read_b128 v[200:203], v240 offset:4096
  ds_read_b128 v[204:207], v240 offset:6144
  s_mov_b32 s49, s52
  s_mov_b32 s58, 1
  s_mov_b32 s59, 0
  s_mov_b32 s57, 100
  s_waitcnt lgkmcnt(0)
  s_branch L_layer
L_final:
  v_lshrrev_b32 v252, 4, v250
  v_and_b32 v254, 15, v252
  v_lshlrev_b32 v253, 11, v254
  v_bfe_u32 v254, v252, 4, 1
  v_lshl_add_u32 v253, v254, 5, v253
  v_lshrrev_b32 v254, 5, v252
  v_lshl_add_u32 v253, v254, 4, v253
  s_mov_b32 s46, s48
  s_add_u32 s53, s48, 32768
  s_add_u32 s56, s48, 65536
  s_add_u32 s57, s48, 98304
  s_waitcnt lgkmcnt(6)
  v_mfma_f32_16x16x32_bf16 v[0:3], v[208:211], v[192:195], v[0:3]
  ds_read_b64_tr_b16 v[224:225], v242 offset:57344
  ds_read_b64_tr_b16 v[226:227], v242 offset:58368
  v_mfma_f32_16x16x32_bf16 v[4:7], v[212:215], v[192:195], v[4:7]
  ds_read_b64_tr_b16 v[228:229], v243 offset:57344
  ds_read_b64_tr_b16 v[230:231], v243 offset:58368
  s_waitcnt lgkmcnt(9)
  v_mfma_f32_16x16x32_bf16 v[8:11], v[216:219], v[192:195], v[8:11]
  ds_read_b64_tr_b16 v[232:233], v244 offset:57344
  ds_read_b64_tr_b16 v[234:235], v244 offset:58368
  s_waitcnt lgkmcnt(9)
  v_mfma_f32_16x16x32_bf16 v[12:15], v[220:223], v[192:195], v[12:15]
  ds_read_b64_tr_b16 v[236:237], v245 offset:57344
  ds_read_b64_tr_b16 v[238:239], v245 offset:58368
  s_waitcnt lgkmcnt(9)
  v_mfma_f32_16x16x32_bf16 v[16:19], v[208:211], v[196:199], v[16:19]
  ds_read_b128 v[192:195], v241 offset:51200
  v_mfma_f32_16x16x32_bf16 v[20:23], v[212:215], v[196:199], v[20:23]
  v_mfma_f32_16x16x32_bf16 v[24:27], v[216:219], v[196:199], v[24:27]
  v_mfma_f32_16x16x32_bf16 v[28:31], v[220:223], v[196:199], v[28:31]
  s_waitcnt lgkmcnt(7)
  v_mfma_f32_16x16x32_bf16 v[0:3], v[224:227], v[200:203], v[0:3]
  ds_read_b128 v[196:199], v240 offset:55296
  s_waitcnt lgkmcnt(6)
  v_mfma_f32_16x16x32_bf16 v[4:7], v[228:231], v[200:203], v[4:7]
  s_waitcnt lgkmcnt(4)
  v_mfma_f32_16x16x32_bf16 v[8:11], v[232:235], v[200:203], v[8:11]
  s_waitcnt lgkmcnt(2)
  v_mfma_f32_16x16x32_bf16 v[12:15], v[236:239], v[200:203], v[12:15]
  v_mfma_f32_16x16x32_bf16 v[32:35], v[208:211], v[204:207], v[32:35]
  ds_read_b128 v[200:203], v241 offset:53248
  v_fma_f32 v128, v64, v0, v128
  v_fma_f32 v129, v65, v1, v129
  v_fma_f32 v130, v66, v2, v130
  v_fma_f32 v131, v67, v3, v131
  v_mfma_f32_16x16x32_bf16 v[36:39], v[212:215], v[204:207], v[36:39]
  v_fma_f32 v132, v68, v4, v132
  v_fma_f32 v133, v69, v5, v133
  v_fma_f32 v134, v70, v6, v134
  v_fma_f32 v135, v71, v7, v135
  v_mfma_f32_16x16x32_bf16 v[40:43], v[216:219], v[204:207], v[40:43]
  v_cvt_pk_bf16_f32 v0, v128, v129
  v_cvt_pk_bf16_f32 v1, v130, v131
  v_cvt_pk_bf16_f32 v2, v132, v133
  v_cvt_pk_bf16_f32 v3, v134, v135
  v_mfma_f32_16x16x32_bf16 v[44:47], v[220:223], v[204:207], v[44:47]
  s_nop 1
  v_permlane16_swap_b32 v0, v2
  v_permlane16_swap_b32 v1, v3
  buffer_store_dwordx4 v[0:3], v253, s[28:31], s46 offen offset:0 sc0 sc1
  v_fma_f32 v136, v72, v8, v136
  v_fma_f32 v137, v73, v9, v137
  s_waitcnt lgkmcnt(2)
  v_mfma_f32_16x16x32_bf16 v[16:19], v[224:227], v[192:195], v[16:19]
  ds_read_b128 v[204:207], v241 offset:55296
  v_fma_f32 v138, v74, v10, v138
  v_fma_f32 v139, v75, v11, v139
  v_fma_f32 v140, v76, v12, v140
  v_fma_f32 v141, v77, v13, v141
  v_mfma_f32_16x16x32_bf16 v[20:23], v[228:231], v[192:195], v[20:23]
  v_fma_f32 v142, v78, v14, v142
  v_fma_f32 v143, v79, v15, v143
  v_cvt_pk_bf16_f32 v8, v136, v137
  v_cvt_pk_bf16_f32 v9, v138, v139
  v_mfma_f32_16x16x32_bf16 v[24:27], v[232:235], v[192:195], v[24:27]
  v_cvt_pk_bf16_f32 v10, v140, v141
  v_cvt_pk_bf16_f32 v11, v142, v143
  s_nop 1
  v_permlane16_swap_b32 v8, v10
  v_permlane16_swap_b32 v9, v11
  buffer_store_dwordx4 v[8:11], v253, s[28:31], s46 offen offset:64 sc0 sc1
  v_mfma_f32_16x16x32_bf16 v[28:31], v[236:239], v[192:195], v[28:31]
  s_waitcnt lgkmcnt(2)
  v_mfma_f32_16x16x32_bf16 v[48:51], v[208:211], v[196:199], v[48:51]
  v_fma_f32 v144, v80, v16, v144
  v_fma_f32 v145, v81, v17, v145
  v_fma_f32 v146, v82, v18, v146
  v_fma_f32 v147, v83, v19, v147
  v_mfma_f32_16x16x32_bf16 v[52:55], v[212:215], v[196:199], v[52:55]
  v_fma_f32 v148, v84, v20, v148
  v_fma_f32 v149, v85, v21, v149
  v_fma_f32 v150, v86, v22, v150
  v_fma_f32 v151, v87, v23, v151
  v_mfma_f32_16x16x32_bf16 v[56:59], v[216:219], v[196:199], v[56:59]
  v_cvt_pk_bf16_f32 v16, v144, v145
  v_cvt_pk_bf16_f32 v17, v146, v147
  v_cvt_pk_bf16_f32 v18, v148, v149
  v_cvt_pk_bf16_f32 v19, v150, v151
  v_mfma_f32_16x16x32_bf16 v[60:63], v[220:223], v[196:199], v[60:63]
  s_waitcnt lgkmcnt(0)
  s_barrier
  s_nop 1
  v_permlane16_swap_b32 v16, v18
  v_permlane16_swap_b32 v17, v19
  buffer_store_dwordx4 v[16:19], v253, s[28:31], s53 offen offset:0 sc0 sc1
  v_fma_f32 v152, v88, v24, v152
  v_fma_f32 v153, v89, v25, v153
  v_mfma_f32_16x16x32_bf16 v[32:35], v[224:227], v[200:203], v[32:35]
  v_fma_f32 v154, v90, v26, v154
  v_fma_f32 v155, v91, v27, v155
  v_fma_f32 v156, v92, v28, v156
  v_fma_f32 v157, v93, v29, v157
  v_mfma_f32_16x16x32_bf16 v[36:39], v[228:231], v[200:203], v[36:39]
  v_fma_f32 v158, v94, v30, v158
  v_fma_f32 v159, v95, v31, v159
  v_cvt_pk_bf16_f32 v24, v152, v153
  v_cvt_pk_bf16_f32 v25, v154, v155
  v_mfma_f32_16x16x32_bf16 v[40:43], v[232:235], v[200:203], v[40:43]
  v_cvt_pk_bf16_f32 v26, v156, v157
  v_cvt_pk_bf16_f32 v27, v158, v159
  s_nop 1
  v_permlane16_swap_b32 v24, v26
  v_permlane16_swap_b32 v25, v27
  buffer_store_dwordx4 v[24:27], v253, s[28:31], s53 offen offset:64 sc0 sc1
  v_mfma_f32_16x16x32_bf16 v[44:47], v[236:239], v[200:203], v[44:47]
  v_mfma_f32_16x16x32_bf16 v[48:51], v[224:227], v[204:207], v[48:51]
  v_fma_f32 v160, v96, v32, v160
  v_fma_f32 v161, v97, v33, v161
  v_fma_f32 v162, v98, v34, v162
  v_fma_f32 v163, v99, v35, v163
  v_mfma_f32_16x16x32_bf16 v[52:55], v[228:231], v[204:207], v[52:55]
  v_fma_f32 v164, v100, v36, v164
  v_fma_f32 v165, v101, v37, v165
  v_fma_f32 v166, v102, v38, v166
  v_fma_f32 v167, v103, v39, v167
  v_mfma_f32_16x16x32_bf16 v[56:59], v[232:235], v[204:207], v[56:59]
  v_cvt_pk_bf16_f32 v32, v160, v161
  v_cvt_pk_bf16_f32 v33, v162, v163
  v_cvt_pk_bf16_f32 v34, v164, v165
  v_cvt_pk_bf16_f32 v35, v166, v167
  v_mfma_f32_16x16x32_bf16 v[60:63], v[236:239], v[204:207], v[60:63]
  s_nop 1
  v_permlane16_swap_b32 v32, v34
  v_permlane16_swap_b32 v33, v35
  buffer_store_dwordx4 v[32:35], v253, s[28:31], s56 offen offset:0 sc0 sc1
  v_fma_f32 v168, v104, v40, v168
  v_fma_f32 v169, v105, v41, v169
  v_pk_fma_f32 v[170:171], v[106:107], v[42:43], v[170:171]
  v_pk_fma_f32 v[172:173], v[108:109], v[44:45], v[172:173]
  v_pk_fma_f32 v[174:175], v[110:111], v[46:47], v[174:175]
  v_cvt_pk_bf16_f32 v40, v168, v169
  v_cvt_pk_bf16_f32 v41, v170, v171
  v_cvt_pk_bf16_f32 v42, v172, v173
  v_cvt_pk_bf16_f32 v43, v174, v175
  s_nop 1
  v_permlane16_swap_b32 v40, v42
  v_permlane16_swap_b32 v41, v43
  buffer_store_dwordx4 v[40:43], v253, s[28:31], s56 offen offset:64 sc0 sc1
  v_pk_fma_f32 v[176:177], v[112:113], v[48:49], v[176:177]
  v_pk_fma_f32 v[178:179], v[114:115], v[50:51], v[178:179]
  v_pk_fma_f32 v[180:181], v[116:117], v[52:53], v[180:181]
  v_pk_fma_f32 v[182:183], v[118:119], v[54:55], v[182:183]
  v_cvt_pk_bf16_f32 v48, v176, v177
  v_cvt_pk_bf16_f32 v49, v178, v179
  v_cvt_pk_bf16_f32 v50, v180, v181
  v_cvt_pk_bf16_f32 v51, v182, v183
  s_nop 1
  v_permlane16_swap_b32 v48, v50
  v_permlane16_swap_b32 v49, v51
  buffer_store_dwordx4 v[48:51], v253, s[28:31], s57 offen offset:0 sc0 sc1
  v_pk_fma_f32 v[184:185], v[120:121], v[56:57], v[184:185]
  v_pk_fma_f32 v[186:187], v[122:123], v[58:59], v[186:187]
  v_pk_fma_f32 v[188:189], v[124:125], v[60:61], v[188:189]
  v_pk_fma_f32 v[190:191], v[126:127], v[62:63], v[190:191]
  v_cvt_pk_bf16_f32 v56, v184, v185
  v_cvt_pk_bf16_f32 v57, v186, v187
  v_cvt_pk_bf16_f32 v58, v188, v189
  v_cvt_pk_bf16_f32 v59, v190, v191
  s_nop 1
  v_permlane16_swap_b32 v56, v58
  v_permlane16_swap_b32 v57, v59
  buffer_store_dwordx4 v[56:59], v253, s[28:31], s57 offen offset:64 sc0 sc1
  s_waitcnt vmcnt(0)
  s_branch L_done
L_x0rd0:
  v_lshrrev_b32 v96, 4, v250
  v_and_b32 v97, 15, v96
  v_lshrrev_b32 v98, 4, v96
  v_and_b32 v99, 7, v97
  v_lshrrev_b32 v100, 1, v98
  s_lshl_b32 s47, s45, 13
  s_add_u32 s47, s47, 0
  v_lshlrev_b32 v101, 7, v97
  v_add_u32 v101, s47, v101
  v_and_b32 v98, 1, v98
  v_lshl_add_u32 v101, v98, 3, v101
  v_add_u32 v102, 0, v100
  v_xor_b32 v102, v102, v99
  v_lshl_add_u32 v64, v102, 4, v101
  v_add_u32 v102, 2, v100
  v_xor_b32 v102, v102, v99
  v_lshl_add_u32 v65, v102, 4, v101
  v_add_u32 v102, 4, v100
  v_xor_b32 v102, v102, v99
  v_lshl_add_u32 v66, v102, 4, v101
  v_add_u32 v102, 6, v100
  v_xor_b32 v102, v102, v99
  v_lshl_add_u32 v67, v102, 4, v101
  ds_read_b64 v[96:97], v64 offset:0
  ds_read_b64 v[98:99], v65 offset:0
  ds_read_b64 v[100:101], v66 offset:0
  ds_read_b64 v[102:103], v67 offset:0
  ds_read_b64 v[104:105], v64 offset:2048
  ds_read_b64 v[106:107], v65 offset:2048
  ds_read_b64 v[108:109], v66 offset:2048
  ds_read_b64 v[110:111], v67 offset:2048
  ds_read_b64 v[112:113], v64 offset:4096
  ds_read_b64 v[114:115], v65 offset:4096
  ds_read_b64 v[116:117], v66 offset:4096
  ds_read_b64 v[118:119], v67 offset:4096
  ds_read_b64 v[120:121], v64 offset:6144
  ds_read_b64 v[122:123], v65 offset:6144
  ds_read_b64 v[124:125], v66 offset:6144
  ds_read_b64 v[126:127], v67 offset:6144
  s_waitcnt lgkmcnt(0)
  v_lshlrev_b32 v64, 16, v96
  v_and_b32 v65, 0xffff0000, v96
  v_lshlrev_b32 v66, 16, v97
  v_and_b32 v67, 0xffff0000, v97
  v_lshlrev_b32 v68, 16, v98
  v_and_b32 v69, 0xffff0000, v98
  v_lshlrev_b32 v70, 16, v99
  v_and_b32 v71, 0xffff0000, v99
  v_lshlrev_b32 v72, 16, v100
  v_and_b32 v73, 0xffff0000, v100
  v_lshlrev_b32 v74, 16, v101
  v_and_b32 v75, 0xffff0000, v101
  v_lshlrev_b32 v76, 16, v102
  v_and_b32 v77, 0xffff0000, v102
  v_lshlrev_b32 v78, 16, v103
  v_and_b32 v79, 0xffff0000, v103
  v_lshlrev_b32 v80, 16, v104
  v_and_b32 v81, 0xffff0000, v104
  v_lshlrev_b32 v82, 16, v105
  v_and_b32 v83, 0xffff0000, v105
  v_lshlrev_b32 v84, 16, v106
  v_and_b32 v85, 0xffff0000, v106
  v_lshlrev_b32 v86, 16, v107
  v_and_b32 v87, 0xffff0000, v107
  v_lshlrev_b32 v88, 16, v108
  v_and_b32 v89, 0xffff0000, v108
  v_lshlrev_b32 v90, 16, v109
  v_and_b32 v91, 0xffff0000, v109
  v_lshlrev_b32 v92, 16, v110
  v_and_b32 v93, 0xffff0000, v110
  v_lshlrev_b32 v94, 16, v111
  v_and_b32 v95, 0xffff0000, v111
  v_lshlrev_b32 v96, 16, v112
  v_and_b32 v97, 0xffff0000, v112
  v_lshlrev_b32 v98, 16, v113
  v_and_b32 v99, 0xffff0000, v113
  v_lshlrev_b32 v100, 16, v114
  v_and_b32 v101, 0xffff0000, v114
  v_lshlrev_b32 v102, 16, v115
  v_and_b32 v103, 0xffff0000, v115
  v_lshlrev_b32 v104, 16, v116
  v_and_b32 v105, 0xffff0000, v116
  v_lshlrev_b32 v106, 16, v117
  v_and_b32 v107, 0xffff0000, v117
  v_lshlrev_b32 v108, 16, v118
  v_and_b32 v109, 0xffff0000, v118
  v_lshlrev_b32 v110, 16, v119
  v_and_b32 v111, 0xffff0000, v119
  v_lshlrev_b32 v112, 16, v120
  v_and_b32 v113, 0xffff0000, v120
  v_lshlrev_b32 v114, 16, v121
  v_and_b32 v115, 0xffff0000, v121
  v_lshlrev_b32 v116, 16, v122
  v_and_b32 v117, 0xffff0000, v122
  v_lshlrev_b32 v118, 16, v123
  v_and_b32 v119, 0xffff0000, v123
  v_lshlrev_b32 v120, 16, v124
  v_and_b32 v121, 0xffff0000, v124
  v_lshlrev_b32 v122, 16, v125
  v_and_b32 v123, 0xffff0000, v125
  v_lshlrev_b32 v124, 16, v126
  v_and_b32 v125, 0xffff0000, v126
  v_lshlrev_b32 v126, 16, v127
  v_and_b32 v127, 0xffff0000, v127
  s_branch L_x0ret0
L_x0rd1:
  v_lshrrev_b32 v96, 4, v250
  v_and_b32 v97, 15, v96
  v_lshrrev_b32 v98, 4, v96
  v_and_b32 v99, 7, v97
  v_lshrrev_b32 v100, 1, v98
  s_lshl_b32 s47, s45, 13
  s_add_u32 s47, s47, 16384
  v_lshlrev_b32 v101, 7, v97
  v_add_u32 v101, s47, v101
  v_and_b32 v98, 1, v98
  v_lshl_add_u32 v101, v98, 3, v101
  v_add_u32 v102, 0, v100
  v_xor_b32 v102, v102, v99
  v_lshl_add_u32 v64, v102, 4, v101
  v_add_u32 v102, 2, v100
  v_xor_b32 v102, v102, v99
  v_lshl_add_u32 v65, v102, 4, v101
  v_add_u32 v102, 4, v100
  v_xor_b32 v102, v102, v99
  v_lshl_add_u32 v66, v102, 4, v101
  v_add_u32 v102, 6, v100
  v_xor_b32 v102, v102, v99
  v_lshl_add_u32 v67, v102, 4, v101
  ds_read_b64 v[96:97], v64 offset:0
  ds_read_b64 v[98:99], v65 offset:0
  ds_read_b64 v[100:101], v66 offset:0
  ds_read_b64 v[102:103], v67 offset:0
  ds_read_b64 v[104:105], v64 offset:2048
  ds_read_b64 v[106:107], v65 offset:2048
  ds_read_b64 v[108:109], v66 offset:2048
  ds_read_b64 v[110:111], v67 offset:2048
  ds_read_b64 v[112:113], v64 offset:4096
  ds_read_b64 v[114:115], v65 offset:4096
  ds_read_b64 v[116:117], v66 offset:4096
  ds_read_b64 v[118:119], v67 offset:4096
  ds_read_b64 v[120:121], v64 offset:6144
  ds_read_b64 v[122:123], v65 offset:6144
  ds_read_b64 v[124:125], v66 offset:6144
  ds_read_b64 v[126:127], v67 offset:6144
  s_waitcnt lgkmcnt(0)
  v_lshlrev_b32 v64, 16, v96
  v_and_b32 v65, 0xffff0000, v96
  v_lshlrev_b32 v66, 16, v97
  v_and_b32 v67, 0xffff0000, v97
  v_lshlrev_b32 v68, 16, v98
  v_and_b32 v69, 0xffff0000, v98
  v_lshlrev_b32 v70, 16, v99
  v_and_b32 v71, 0xffff0000, v99
  v_lshlrev_b32 v72, 16, v100
  v_and_b32 v73, 0xffff0000, v100
  v_lshlrev_b32 v74, 16, v101
  v_and_b32 v75, 0xffff0000, v101
  v_lshlrev_b32 v76, 16, v102
  v_and_b32 v77, 0xffff0000, v102
  v_lshlrev_b32 v78, 16, v103
  v_and_b32 v79, 0xffff0000, v103
  v_lshlrev_b32 v80, 16, v104
  v_and_b32 v81, 0xffff0000, v104
  v_lshlrev_b32 v82, 16, v105
  v_and_b32 v83, 0xffff0000, v105
  v_lshlrev_b32 v84, 16, v106
  v_and_b32 v85, 0xffff0000, v106
  v_lshlrev_b32 v86, 16, v107
  v_and_b32 v87, 0xffff0000, v107
  v_lshlrev_b32 v88, 16, v108
  v_and_b32 v89, 0xffff0000, v108
  v_lshlrev_b32 v90, 16, v109
  v_and_b32 v91, 0xffff0000, v109
  v_lshlrev_b32 v92, 16, v110
  v_and_b32 v93, 0xffff0000, v110
  v_lshlrev_b32 v94, 16, v111
  v_and_b32 v95, 0xffff0000, v111
  v_lshlrev_b32 v96, 16, v112
  v_and_b32 v97, 0xffff0000, v112
  v_lshlrev_b32 v98, 16, v113
  v_and_b32 v99, 0xffff0000, v113
  v_lshlrev_b32 v100, 16, v114
  v_and_b32 v101, 0xffff0000, v114
  v_lshlrev_b32 v102, 16, v115
  v_and_b32 v103, 0xffff0000, v115
  v_lshlrev_b32 v104, 16, v116
  v_and_b32 v105, 0xffff0000, v116
  v_lshlrev_b32 v106, 16, v117
  v_and_b32 v107, 0xffff0000, v117
  v_lshlrev_b32 v108, 16, v118
  v_and_b32 v109, 0xffff0000, v118
  v_lshlrev_b32 v110, 16, v119
  v_and_b32 v111, 0xffff0000, v119
  v_lshlrev_b32 v112, 16, v120
  v_and_b32 v113, 0xffff0000, v120
  v_lshlrev_b32 v114, 16, v121
  v_and_b32 v115, 0xffff0000, v121
  v_lshlrev_b32 v116, 16, v122
  v_and_b32 v117, 0xffff0000, v122
  v_lshlrev_b32 v118, 16, v123
  v_and_b32 v119, 0xffff0000, v123
  v_lshlrev_b32 v120, 16, v124
  v_and_b32 v121, 0xffff0000, v124
  v_lshlrev_b32 v122, 16, v125
  v_and_b32 v123, 0xffff0000, v125
  v_lshlrev_b32 v124, 16, v126
  v_and_b32 v125, 0xffff0000, v126
  v_lshlrev_b32 v126, 16, v127
  v_and_b32 v127, 0xffff0000, v127
  s_branch L_x0ret1
L_x0rd2:
  v_lshrrev_b32 v96, 4, v250
  v_and_b32 v97, 15, v96
  v_lshrrev_b32 v98, 4, v96
  v_and_b32 v99, 7, v97
  v_lshrrev_b32 v100, 1, v98
  s_lshl_b32 s47, s45, 13
  s_add_u32 s47, s47, 32768
  v_lshlrev_b32 v101, 7, v97
  v_add_u32 v101, s47, v101
  v_and_b32 v98, 1, v98
  v_lshl_add_u32 v101, v98, 3, v101
  v_add_u32 v102, 0, v100
  v_xor_b32 v102, v102, v99
  v_lshl_add_u32 v64, v102, 4, v101
  v_add_u32 v102, 2, v100
  v_xor_b32 v102, v102, v99
  v_lshl_add_u32 v65, v102, 4, v101
  v_add_u32 v102, 4, v100
  v_xor_b32 v102, v102, v99
  v_lshl_add_u32 v66, v102, 4, v101
  v_add_u32 v102, 6, v100
  v_xor_b32 v102, v102, v99
  v_lshl_add_u32 v67, v102, 4, v101
  ds_read_b64 v[96:97], v64 offset:0
  ds_read_b64 v[98:99], v65 offset:0
  ds_read_b64 v[100:101], v66 offset:0
  ds_read_b64 v[102:103], v67 offset:0
  ds_read_b64 v[104:105], v64 offset:2048
  ds_read_b64 v[106:107], v65 offset:2048
  ds_read_b64 v[108:109], v66 offset:2048
  ds_read_b64 v[110:111], v67 offset:2048
  ds_read_b64 v[112:113], v64 offset:4096
  ds_read_b64 v[114:115], v65 offset:4096
  ds_read_b64 v[116:117], v66 offset:4096
  ds_read_b64 v[118:119], v67 offset:4096
  ds_read_b64 v[120:121], v64 offset:6144
  ds_read_b64 v[122:123], v65 offset:6144
  ds_read_b64 v[124:125], v66 offset:6144
  ds_read_b64 v[126:127], v67 offset:6144
  s_waitcnt lgkmcnt(0)
  v_lshlrev_b32 v64, 16, v96
  v_and_b32 v65, 0xffff0000, v96
  v_lshlrev_b32 v66, 16, v97
  v_and_b32 v67, 0xffff0000, v97
  v_lshlrev_b32 v68, 16, v98
  v_and_b32 v69, 0xffff0000, v98
  v_lshlrev_b32 v70, 16, v99
  v_and_b32 v71, 0xffff0000, v99
  v_lshlrev_b32 v72, 16, v100
  v_and_b32 v73, 0xffff0000, v100
  v_lshlrev_b32 v74, 16, v101
  v_and_b32 v75, 0xffff0000, v101
  v_lshlrev_b32 v76, 16, v102
  v_and_b32 v77, 0xffff0000, v102
  v_lshlrev_b32 v78, 16, v103
  v_and_b32 v79, 0xffff0000, v103
  v_lshlrev_b32 v80, 16, v104
  v_and_b32 v81, 0xffff0000, v104
  v_lshlrev_b32 v82, 16, v105
  v_and_b32 v83, 0xffff0000, v105
  v_lshlrev_b32 v84, 16, v106
  v_and_b32 v85, 0xffff0000, v106
  v_lshlrev_b32 v86, 16, v107
  v_and_b32 v87, 0xffff0000, v107
  v_lshlrev_b32 v88, 16, v108
  v_and_b32 v89, 0xffff0000, v108
  v_lshlrev_b32 v90, 16, v109
  v_and_b32 v91, 0xffff0000, v109
  v_lshlrev_b32 v92, 16, v110
  v_and_b32 v93, 0xffff0000, v110
  v_lshlrev_b32 v94, 16, v111
  v_and_b32 v95, 0xffff0000, v111
  v_lshlrev_b32 v96, 16, v112
  v_and_b32 v97, 0xffff0000, v112
  v_lshlrev_b32 v98, 16, v113
  v_and_b32 v99, 0xffff0000, v113
  v_lshlrev_b32 v100, 16, v114
  v_and_b32 v101, 0xffff0000, v114
  v_lshlrev_b32 v102, 16, v115
  v_and_b32 v103, 0xffff0000, v115
  v_lshlrev_b32 v104, 16, v116
  v_and_b32 v105, 0xffff0000, v116
  v_lshlrev_b32 v106, 16, v117
  v_and_b32 v107, 0xffff0000, v117
  v_lshlrev_b32 v108, 16, v118
  v_and_b32 v109, 0xffff0000, v118
  v_lshlrev_b32 v110, 16, v119
  v_and_b32 v111, 0xffff0000, v119
  v_lshlrev_b32 v112, 16, v120
  v_and_b32 v113, 0xffff0000, v120
  v_lshlrev_b32 v114, 16, v121
  v_and_b32 v115, 0xffff0000, v121
  v_lshlrev_b32 v116, 16, v122
  v_and_b32 v117, 0xffff0000, v122
  v_lshlrev_b32 v118, 16, v123
  v_and_b32 v119, 0xffff0000, v123
  v_lshlrev_b32 v120, 16, v124
  v_and_b32 v121, 0xffff0000, v124
  v_lshlrev_b32 v122, 16, v125
  v_and_b32 v123, 0xffff0000, v125
  v_lshlrev_b32 v124, 16, v126
  v_and_b32 v125, 0xffff0000, v126
  v_lshlrev_b32 v126, 16, v127
  v_and_b32 v127, 0xffff0000, v127
  s_branch L_x0ret2
L_x0rd3:
  v_lshrrev_b32 v96, 4, v250
  v_and_b32 v97, 15, v96
  v_lshrrev_b32 v98, 4, v96
  v_and_b32 v99, 7, v97
  v_lshrrev_b32 v100, 1, v98
  s_lshl_b32 s47, s45, 13
  s_add_u32 s47, s47, 49152
  v_lshlrev_b32 v101, 7, v97
  v_add_u32 v101, s47, v101
  v_and_b32 v98, 1, v98
  v_lshl_add_u32 v101, v98, 3, v101
  v_add_u32 v102, 0, v100
  v_xor_b32 v102, v102, v99
  v_lshl_add_u32 v64, v102, 4, v101
  v_add_u32 v102, 2, v100
  v_xor_b32 v102, v102, v99
  v_lshl_add_u32 v65, v102, 4, v101
  v_add_u32 v102, 4, v100
  v_xor_b32 v102, v102, v99
  v_lshl_add_u32 v66, v102, 4, v101
  v_add_u32 v102, 6, v100
  v_xor_b32 v102, v102, v99
  v_lshl_add_u32 v67, v102, 4, v101
  ds_read_b64 v[96:97], v64 offset:0
  ds_read_b64 v[98:99], v65 offset:0
  ds_read_b64 v[100:101], v66 offset:0
  ds_read_b64 v[102:103], v67 offset:0
  ds_read_b64 v[104:105], v64 offset:2048
  ds_read_b64 v[106:107], v65 offset:2048
  ds_read_b64 v[108:109], v66 offset:2048
  ds_read_b64 v[110:111], v67 offset:2048
  ds_read_b64 v[112:113], v64 offset:4096
  ds_read_b64 v[114:115], v65 offset:4096
  ds_read_b64 v[116:117], v66 offset:4096
  ds_read_b64 v[118:119], v67 offset:4096
  ds_read_b64 v[120:121], v64 offset:6144
  ds_read_b64 v[122:123], v65 offset:6144
  ds_read_b64 v[124:125], v66 offset:6144
  ds_read_b64 v[126:127], v67 offset:6144
  s_waitcnt lgkmcnt(0)
  v_lshlrev_b32 v64, 16, v96
  v_and_b32 v65, 0xffff0000, v96
  v_lshlrev_b32 v66, 16, v97
  v_and_b32 v67, 0xffff0000, v97
  v_lshlrev_b32 v68, 16, v98
  v_and_b32 v69, 0xffff0000, v98
  v_lshlrev_b32 v70, 16, v99
  v_and_b32 v71, 0xffff0000, v99
  v_lshlrev_b32 v72, 16, v100
  v_and_b32 v73, 0xffff0000, v100
  v_lshlrev_b32 v74, 16, v101
  v_and_b32 v75, 0xffff0000, v101
  v_lshlrev_b32 v76, 16, v102
  v_and_b32 v77, 0xffff0000, v102
  v_lshlrev_b32 v78, 16, v103
  v_and_b32 v79, 0xffff0000, v103
  v_lshlrev_b32 v80, 16, v104
  v_and_b32 v81, 0xffff0000, v104
  v_lshlrev_b32 v82, 16, v105
  v_and_b32 v83, 0xffff0000, v105
  v_lshlrev_b32 v84, 16, v106
  v_and_b32 v85, 0xffff0000, v106
  v_lshlrev_b32 v86, 16, v107
  v_and_b32 v87, 0xffff0000, v107
  v_lshlrev_b32 v88, 16, v108
  v_and_b32 v89, 0xffff0000, v108
  v_lshlrev_b32 v90, 16, v109
  v_and_b32 v91, 0xffff0000, v109
  v_lshlrev_b32 v92, 16, v110
  v_and_b32 v93, 0xffff0000, v110
  v_lshlrev_b32 v94, 16, v111
  v_and_b32 v95, 0xffff0000, v111
  v_lshlrev_b32 v96, 16, v112
  v_and_b32 v97, 0xffff0000, v112
  v_lshlrev_b32 v98, 16, v113
  v_and_b32 v99, 0xffff0000, v113
  v_lshlrev_b32 v100, 16, v114
  v_and_b32 v101, 0xffff0000, v114
  v_lshlrev_b32 v102, 16, v115
  v_and_b32 v103, 0xffff0000, v115
  v_lshlrev_b32 v104, 16, v116
  v_and_b32 v105, 0xffff0000, v116
  v_lshlrev_b32 v106, 16, v117
  v_and_b32 v107, 0xffff0000, v117
  v_lshlrev_b32 v108, 16, v118
  v_and_b32 v109, 0xffff0000, v118
  v_lshlrev_b32 v110, 16, v119
  v_and_b32 v111, 0xffff0000, v119
  v_lshlrev_b32 v112, 16, v120
  v_and_b32 v113, 0xffff0000, v120
  v_lshlrev_b32 v114, 16, v121
  v_and_b32 v115, 0xffff0000, v121
  v_lshlrev_b32 v116, 16, v122
  v_and_b32 v117, 0xffff0000, v122
  v_lshlrev_b32 v118, 16, v123
  v_and_b32 v119, 0xffff0000, v123
  v_lshlrev_b32 v120, 16, v124
  v_and_b32 v121, 0xffff0000, v124
  v_lshlrev_b32 v122, 16, v125
  v_and_b32 v123, 0xffff0000, v125
  v_lshlrev_b32 v124, 16, v126
  v_and_b32 v125, 0xffff0000, v126
  v_lshlrev_b32 v126, 16, v127
  v_and_b32 v127, 0xffff0000, v127
  s_branch L_x0ret3
L_x0rdT:
  v_lshrrev_b32 v96, 4, v250
  v_and_b32 v97, 15, v96
  v_lshrrev_b32 v98, 4, v96
  v_and_b32 v99, 7, v97
  v_lshrrev_b32 v100, 1, v98
  s_lshl_b32 s47, s45, 13
  s_add_u32 s47, s47, 49152
  v_lshlrev_b32 v101, 7, v97
  v_add_u32 v101, s47, v101
  v_and_b32 v98, 1, v98
  v_lshl_add_u32 v101, v98, 3, v101
  v_add_u32 v102, 0, v100
  v_xor_b32 v102, v102, v99
  v_lshl_add_u32 v64, v102, 4, v101
  v_add_u32 v102, 2, v100
  v_xor_b32 v102, v102, v99
  v_lshl_add_u32 v65, v102, 4, v101
  v_add_u32 v102, 4, v100
  v_xor_b32 v102, v102, v99
  v_lshl_add_u32 v66, v102, 4, v101
  v_add_u32 v102, 6, v100
  v_xor_b32 v102, v102, v99
  v_lshl_add_u32 v67, v102, 4, v101
  ds_read_b64 v[96:97], v64 offset:0
  ds_read_b64 v[98:99], v65 offset:0
  ds_read_b64 v[100:101], v66 offset:0
  ds_read_b64 v[102:103], v67 offset:0
  ds_read_b64 v[104:105], v64 offset:2048
  ds_read_b64 v[106:107], v65 offset:2048
  ds_read_b64 v[108:109], v66 offset:2048
  ds_read_b64 v[110:111], v67 offset:2048
  ds_read_b64 v[112:113], v64 offset:4096
  ds_read_b64 v[114:115], v65 offset:4096
  ds_read_b64 v[116:117], v66 offset:4096
  ds_read_b64 v[118:119], v67 offset:4096
  ds_read_b64 v[120:121], v64 offset:6144
  ds_read_b64 v[122:123], v65 offset:6144
  ds_read_b64 v[124:125], v66 offset:6144
  ds_read_b64 v[126:127], v67 offset:6144
  s_waitcnt lgkmcnt(0)
  v_lshlrev_b32 v64, 16, v96
  v_and_b32 v65, 0xffff0000, v96
  v_lshlrev_b32 v66, 16, v97
  v_and_b32 v67, 0xffff0000, v97
  v_lshlrev_b32 v68, 16, v98
  v_and_b32 v69, 0xffff0000, v98
  v_lshlrev_b32 v70, 16, v99
  v_and_b32 v71, 0xffff0000, v99
  v_lshlrev_b32 v72, 16, v100
  v_and_b32 v73, 0xffff0000, v100
  v_lshlrev_b32 v74, 16, v101
  v_and_b32 v75, 0xffff0000, v101
  v_lshlrev_b32 v76, 16, v102
  v_and_b32 v77, 0xffff0000, v102
  v_lshlrev_b32 v78, 16, v103
  v_and_b32 v79, 0xffff0000, v103
  v_lshlrev_b32 v80, 16, v104
  v_and_b32 v81, 0xffff0000, v104
  v_lshlrev_b32 v82, 16, v105
  v_and_b32 v83, 0xffff0000, v105
  v_lshlrev_b32 v84, 16, v106
  v_and_b32 v85, 0xffff0000, v106
  v_lshlrev_b32 v86, 16, v107
  v_and_b32 v87, 0xffff0000, v107
  v_lshlrev_b32 v88, 16, v108
  v_and_b32 v89, 0xffff0000, v108
  v_lshlrev_b32 v90, 16, v109
  v_and_b32 v91, 0xffff0000, v109
  v_lshlrev_b32 v92, 16, v110
  v_and_b32 v93, 0xffff0000, v110
  v_lshlrev_b32 v94, 16, v111
  v_and_b32 v95, 0xffff0000, v111
  v_lshlrev_b32 v96, 16, v112
  v_and_b32 v97, 0xffff0000, v112
  v_lshlrev_b32 v98, 16, v113
  v_and_b32 v99, 0xffff0000, v113
  v_lshlrev_b32 v100, 16, v114
  v_and_b32 v101, 0xffff0000, v114
  v_lshlrev_b32 v102, 16, v115
  v_and_b32 v103, 0xffff0000, v115
  v_lshlrev_b32 v104, 16, v116
  v_and_b32 v105, 0xffff0000, v116
  v_lshlrev_b32 v106, 16, v117
  v_and_b32 v107, 0xffff0000, v117
  v_lshlrev_b32 v108, 16, v118
  v_and_b32 v109, 0xffff0000, v118
  v_lshlrev_b32 v110, 16, v119
  v_and_b32 v111, 0xffff0000, v119
  v_lshlrev_b32 v112, 16, v120
  v_and_b32 v113, 0xffff0000, v120
  v_lshlrev_b32 v114, 16, v121
  v_and_b32 v115, 0xffff0000, v121
  v_lshlrev_b32 v116, 16, v122
  v_and_b32 v117, 0xffff0000, v122
  v_lshlrev_b32 v118, 16, v123
  v_and_b32 v119, 0xffff0000, v123
  v_lshlrev_b32 v120, 16, v124
  v_and_b32 v121, 0xffff0000, v124
  v_lshlrev_b32 v122, 16, v125
  v_and_b32 v123, 0xffff0000, v125
  v_lshlrev_b32 v124, 16, v126
  v_and_b32 v125, 0xffff0000, v126
  v_lshlrev_b32 v126, 16, v127
  v_and_b32 v127, 0xffff0000, v127
  s_branch L_x0retT
L_x0special:
  s_lshl_b32 s47, s41, 2
  s_add_u32 s47, s47, 128
  s_cmp_eq_u32 s50, 3
  s_cbranch_scc1 L_modechk
  s_cmp_lg_u32 s50, 2
  s_cbranch_scc1 L_nox0
  v_mov_b32 v254, 0
  buffer_load_dword v254, v254, s[36:39], s47 offen sc1
  s_branch L_nox0
L_modechk:
  s_mov_b32 s56, 200000
L_carr:
  s_waitcnt vmcnt(0)
  v_readfirstlane_b32 s52, v254
  s_nop 3
  s_and_b32 s53, s52, 0x0f0f0f0f
  s_lshr_b32 s46, s52, 4
  s_and_b32 s46, s46, 0x0f0f0f0f
  s_add_u32 s53, s53, s46
  s_mul_i32 s53, s53, 0x01010101
  s_lshr_b32 s53, s53, 24
  s_cmp_ge_u32 s53, 8
  s_cbranch_scc1 L_carrok
  s_cmp_eq_u32 s56, 0
  s_cbranch_scc1 L_carrok
  s_sub_u32 s56, s56, 1
  v_mov_b32 v254, 0
  buffer_load_dword v254, v254, s[36:39], s47 offen sc1
  s_branch L_carr
L_carrok:
  s_lshl_b32 s53, 8, s54
  s_cmp_eq_u32 s52, s53
  s_cselect_b32 s55, 1, 0
  s_branch L_nox0
L_loader:
  s_sub_u32 s44, s40, 4
  s_lshl_b32 s45, s44, 12
  s_add_u32 s58, s45, 65536
  v_lshrrev_b32 v4, 4, v252
  v_and_b32 v9, 15, v252
  v_lshlrev_b32 v10, 1, v4
  v_xor_b32 v9, v9, v10
  v_lshlrev_b32 v9, 4, v9
  v_lshl_add_u32 v10, v4, 11, v9
  v_xor_b32 v11, 128, v10
  s_lshr_b32 s47, s44, 1
  s_lshl_b32 s59, s47, 16
  s_and_b32 s52, s44, 1
  s_lshl_b32 s47, s52, 15
  s_add_u32 s47, s47, s59
  s_add_u32 s43, s47, 0
  v_add_u32 v26, s43, v10
  s_add_u32 s43, s47, 7168
  v_add_u32 v27, s43, v10
  s_add_u32 s43, s47, 14336
  v_add_u32 v28, s43, v11
  s_add_u32 s43, s47, 21504
  v_add_u32 v29, s43, v11
  v_lshrrev_b32 v3, 3, v252
  v_and_b32 v4, 7, v252
  v_xor_b32 v4, v4, v3
  v_lshlrev_b32 v4, 4, v4
  v_lshl_add_u32 v30, v3, 11, v4
  v_add_u32 v31, 15360, v30
  v_add_u32 v32, 30720, v30
  v_add_u32 v33, 46080, v30
  s_lshl_b32 s46, s41, 7
  s_lshl_b32 s47, s44, 5
  s_add_u32 s46, s46, s47
  s_lshl_b32 s46, s46, 11
  s_lshl_b32 s49, s42, 8
  s_sub_u32 s22, 12582912, s49
  s_mov_b32 s23, 0x00020000
  s_sub_u32 s18, 8388608, s46
  s_mov_b32 s19, 0x00020000
  s_waitcnt lgkmcnt(0)
  s_add_u32 s20, s6, s49
  s_addc_u32 s21, s7, 0
  s_and_b32 s21, s21, 0xffff
  s_add_u32 s16, s4, s46
  s_addc_u32 s17, s5, 0
  s_and_b32 s17, s17, 0xffff
  s_lshl_b32 s47, s96, 1
  s_add_u32 s47, s47, 0
  s_and_b32 s47, s47, 15
  s_lshl_b32 s60, s47, 17
  s_lshl_b32 s32, s47, 7
  s_add_u32 m0, s58, 0
  s_nop 0
  buffer_load_dwordx4 v26, s[20:23], s60 offen offset:0 lds
  buffer_load_dwordx4 v27, s[20:23], s60 offen offset:1024 lds
  buffer_load_dwordx4 v28, s[20:23], s60 offen offset:2048 lds
  buffer_load_dwordx4 v29, s[20:23], s60 offen offset:3072 lds
  s_add_u32 m0, s45, 0
  s_nop 0
  buffer_load_dwordx4 v30, s[16:19], s32 offen offset:0 lds
  buffer_load_dwordx4 v31, s[16:19], s32 offen offset:1024 lds
  buffer_load_dwordx4 v32, s[16:19], s32 offen offset:2048 lds
  buffer_load_dwordx4 v33, s[16:19], s32 offen offset:3072 lds
  s_lshl_b32 s47, s96, 1
  s_add_u32 s47, s47, 1
  s_and_b32 s47, s47, 15
  s_lshl_b32 s61, s47, 17
  s_lshl_b32 s33, s47, 7
  s_add_u32 m0, s58, 16384
  s_nop 0
  buffer_load_dwordx4 v26, s[20:23], s61 offen offset:0 lds
  buffer_load_dwordx4 v27, s[20:23], s61 offen offset:1024 lds
  buffer_load_dwordx4 v28, s[20:23], s61 offen offset:2048 lds
  buffer_load_dwordx4 v29, s[20:23], s61 offen offset:3072 lds
  s_add_u32 m0, s45, 16384
  s_nop 0
  buffer_load_dwordx4 v30, s[16:19], s33 offen offset:0 lds
  buffer_load_dwordx4 v31, s[16:19], s33 offen offset:1024 lds
  buffer_load_dwordx4 v32, s[16:19], s33 offen offset:2048 lds
  buffer_load_dwordx4 v33, s[16:19], s33 offen offset:3072 lds
  s_lshl_b32 s47, s96, 1
  v_add_u32 v25, s47, v252
  v_and_b32 v25, 15, v25
  v_lshlrev_b32 v22, 7, v25
  v_lshlrev_b32 v23, 17, v25
  s_mov_b32 s24, s14
  s_and_b32 s25, s15, 0xffff
  s_mov_b32 s26, 268435456
  s_mov_b32 s27, 0x00020000
  s_mov_b32 s36, s12
  s_and_b32 s37, s13, 0xffff
  s_mov_b32 s38, 256
  s_mov_b32 s39, 0x00020000
  v_lshlrev_b32 v5, 4, v252
  v_lshlrev_b32 v6, 2, v252
  v_mov_b32 v8, 0
  v_mov_b32 v7, 0
  v_readlane_b32 s62, v23, 2
  v_readlane_b32 s63, v23, 3
  v_readlane_b32 s64, v23, 4
  v_readlane_b32 s65, v23, 5
  v_readlane_b32 s66, v23, 6
  v_readlane_b32 s67, v23, 7
  v_readlane_b32 s68, v23, 8
  v_readlane_b32 s69, v23, 9
  v_readlane_b32 s70, v23, 10
  v_readlane_b32 s71, v23, 11
  v_readlane_b32 s72, v23, 12
  v_readlane_b32 s73, v23, 13
  v_readlane_b32 s74, v23, 14
  v_readlane_b32 s75, v23, 15
  v_readlane_b32 s34, v22, 2
  v_readlane_b32 s35, v22, 3
  v_readlane_b32 s76, v22, 4
  v_readlane_b32 s77, v22, 5
  v_readlane_b32 s78, v22, 6
  v_readlane_b32 s79, v22, 7
  v_readlane_b32 s80, v22, 8
  v_readlane_b32 s81, v22, 9
  v_readlane_b32 s82, v22, 10
  v_readlane_b32 s83, v22, 11
  v_readlane_b32 s84, v22, 12
  v_readlane_b32 s85, v22, 13
  v_readlane_b32 s92, v22, 14
  v_readlane_b32 s93, v22, 15
  s_nop 4
  s_lshl_b32 s49, s41, 3
  s_add_u32 s49, s49, s42
  s_lshl_b32 s49, s49, 2
  s_add_u32 s49, s49, s44
  s_lshl_b32 s49, s49, 11
  s_add_u32 s49, s49, 2097152
  s_add_u32 s90, s6, s49
  s_addc_u32 s91, s7, 0
  s_waitcnt vmcnt(8)
  s_barrier
  s_add_u32 m0, s58, 32768
  s_nop 0
  buffer_load_dwordx4 v26, s[20:23], s62 offen offset:0 lds
  buffer_load_dwordx4 v27, s[20:23], s62 offen offset:1024 lds
  buffer_load_dwordx4 v28, s[20:23], s62 offen offset:2048 lds
  buffer_load_dwordx4 v29, s[20:23], s62 offen offset:3072 lds
  s_add_u32 m0, s45, 32768
  s_nop 0
  buffer_load_dwordx4 v30, s[16:19], s34 offen offset:0 lds
  buffer_load_dwordx4 v31, s[16:19], s34 offen offset:1024 lds
  buffer_load_dwordx4 v32, s[16:19], s34 offen offset:2048 lds
  buffer_load_dwordx4 v33, s[16:19], s34 offen offset:3072 lds
  s_add_u32 m0, s58, 49152
  s_nop 0
  buffer_load_dwordx4 v26, s[20:23], s63 offen offset:0 lds
  buffer_load_dwordx4 v27, s[20:23], s63 offen offset:1024 lds
  buffer_load_dwordx4 v28, s[20:23], s63 offen offset:2048 lds
  buffer_load_dwordx4 v29, s[20:23], s63 offen offset:3072 lds
  s_add_u32 m0, s45, 49152
  s_nop 0
  buffer_load_dwordx4 v30, s[16:19], s35 offen offset:0 lds
  buffer_load_dwordx4 v31, s[16:19], s35 offen offset:1024 lds
  buffer_load_dwordx4 v32, s[16:19], s35 offen offset:2048 lds
  buffer_load_dwordx4 v33, s[16:19], s35 offen offset:3072 lds
  s_load_dword s86, s[90:91], 0
  s_load_dword s86, s[90:91], 64
  s_load_dword s86, s[90:91], 128
  s_load_dword s86, s[90:91], 192
  s_load_dword s86, s[90:91], 256
  s_load_dword s86, s[90:91], 320
  s_load_dword s86, s[90:91], 384
  s_load_dword s86, s[90:91], 448
  s_load_dword s86, s[90:91], 512
  s_load_dword s86, s[90:91], 576
  s_load_dword s86, s[90:91], 640
  s_add_u32 m0, s58, 0
  s_waitcnt vmcnt(16)
  s_barrier
  buffer_load_dwordx4 v26, s[20:23], s64 offen offset:0 lds
  buffer_load_dwordx4 v27, s[20:23], s64 offen offset:1024 lds
  buffer_load_dwordx4 v28, s[20:23], s64 offen offset:2048 lds
  buffer_load_dwordx4 v29, s[20:23], s64 offen offset:3072 lds
  s_add_u32 m0, s45, 0
  s_nop 0
  buffer_load_dwordx4 v30, s[16:19], s76 offen offset:0 lds
  buffer_load_dwordx4 v31, s[16:19], s76 offen offset:1024 lds
  buffer_load_dwordx4 v32, s[16:19], s76 offen offset:2048 lds
  buffer_load_dwordx4 v33, s[16:19], s76 offen offset:3072 lds
  s_add_u32 m0, s58, 16384
  s_waitcnt vmcnt(16)
  s_barrier
  buffer_load_dwordx4 v26, s[20:23], s65 offen offset:0 lds
  buffer_load_dwordx4 v27, s[20:23], s65 offen offset:1024 lds
  buffer_load_dwordx4 v28, s[20:23], s65 offen offset:2048 lds
  buffer_load_dwordx4 v29, s[20:23], s65 offen offset:3072 lds
  s_add_u32 m0, s45, 16384
  s_nop 0
  buffer_load_dwordx4 v30, s[16:19], s77 offen offset:0 lds
  buffer_load_dwordx4 v31, s[16:19], s77 offen offset:1024 lds
  buffer_load_dwordx4 v32, s[16:19], s77 offen offset:2048 lds
  buffer_load_dwordx4 v33, s[16:19], s77 offen offset:3072 lds
  s_add_u32 m0, s58, 32768
  s_waitcnt vmcnt(16)
  s_barrier
  buffer_load_dwordx4 v26, s[20:23], s66 offen offset:0 lds
  buffer_load_dwordx4 v27, s[20:23], s66 offen offset:1024 lds
  buffer_load_dwordx4 v28, s[20:23], s66 offen offset:2048 lds
  buffer_load_dwordx4 v29, s[20:23], s66 offen offset:3072 lds
  s_add_u32 m0, s45, 32768
  s_nop 0
  buffer_load_dwordx4 v30, s[16:19], s78 offen offset:0 lds
  buffer_load_dwordx4 v31, s[16:19], s78 offen offset:1024 lds
  buffer_load_dwordx4 v32, s[16:19], s78 offen offset:2048 lds
  buffer_load_dwordx4 v33, s[16:19], s78 offen offset:3072 lds
  s_add_u32 m0, s58, 49152
  s_waitcnt vmcnt(16)
  s_barrier
  buffer_load_dwordx4 v26, s[20:23], s67 offen offset:0 lds
  buffer_load_dwordx4 v27, s[20:23], s67 offen offset:1024 lds
  buffer_load_dwordx4 v28, s[20:23], s67 offen offset:2048 lds
  buffer_load_dwordx4 v29, s[20:23], s67 offen offset:3072 lds
  s_add_u32 m0, s45, 49152
  s_nop 0
  buffer_load_dwordx4 v30, s[16:19], s79 offen offset:0 lds
  buffer_load_dwordx4 v31, s[16:19], s79 offen offset:1024 lds
  buffer_load_dwordx4 v32, s[16:19], s79 offen offset:2048 lds
  buffer_load_dwordx4 v33, s[16:19], s79 offen offset:3072 lds
  s_add_u32 m0, s58, 0
  s_waitcnt vmcnt(16)
  s_barrier
  buffer_load_dwordx4 v26, s[20:23], s68 offen offset:0 lds
  buffer_load_dwordx4 v27, s[20:23], s68 offen offset:1024 lds
  buffer_load_dwordx4 v28, s[20:23], s68 offen offset:2048 lds
  buffer_load_dwordx4 v29, s[20:23], s68 offen offset:3072 lds
  s_add_u32 m0, s45, 0
  s_nop 0
  buffer_load_dwordx4 v30, s[16:19], s80 offen offset:0 lds
  buffer_load_dwordx4 v31, s[16:19], s80 offen offset:1024 lds
  buffer_load_dwordx4 v32, s[16:19], s80 offen offset:2048 lds
  buffer_load_dwordx4 v33, s[16:19], s80 offen offset:3072 lds
  s_load_dword s86, s[90:91], 704
  s_load_dword s86, s[90:91], 768
  s_load_dword s86, s[90:91], 832
  s_load_dword s86, s[90:91], 896
  s_load_dword s86, s[90:91], 960
  s_load_dword s86, s[90:91], 1024
  s_load_dword s86, s[90:91], 1088
  s_load_dword s86, s[90:91], 1152
  s_load_dword s86, s[90:91], 1216
  s_load_dword s86, s[90:91], 1280
  s_load_dword s86, s[90:91], 1344
  s_add_u32 m0, s58, 16384
  s_waitcnt vmcnt(16)
  s_barrier
  buffer_load_dwordx4 v26, s[20:23], s69 offen offset:0 lds
  buffer_load_dwordx4 v27, s[20:23], s69 offen offset:1024 lds
  buffer_load_dwordx4 v28, s[20:23], s69 offen offset:2048 lds
  buffer_load_dwordx4 v29, s[20:23], s69 offen offset:3072 lds
  s_add_u32 m0, s45, 16384
  s_nop 0
  buffer_load_dwordx4 v30, s[16:19], s81 offen offset:0 lds
  buffer_load_dwordx4 v31, s[16:19], s81 offen offset:1024 lds
  buffer_load_dwordx4 v32, s[16:19], s81 offen offset:2048 lds
  buffer_load_dwordx4 v33, s[16:19], s81 offen offset:3072 lds
  s_add_u32 m0, s58, 32768
  s_waitcnt vmcnt(16)
  s_barrier
  buffer_load_dwordx4 v26, s[20:23], s70 offen offset:0 lds
  buffer_load_dwordx4 v27, s[20:23], s70 offen offset:1024 lds
  buffer_load_dwordx4 v28, s[20:23], s70 offen offset:2048 lds
  buffer_load_dwordx4 v29, s[20:23], s70 offen offset:3072 lds
  s_add_u32 m0, s45, 32768
  s_nop 0
  buffer_load_dwordx4 v30, s[16:19], s82 offen offset:0 lds
  buffer_load_dwordx4 v31, s[16:19], s82 offen offset:1024 lds
  buffer_load_dwordx4 v32, s[16:19], s82 offen offset:2048 lds
  buffer_load_dwordx4 v33, s[16:19], s82 offen offset:3072 lds
  s_add_u32 m0, s58, 49152
  s_waitcnt vmcnt(16)
  s_barrier
  buffer_load_dwordx4 v26, s[20:23], s71 offen offset:0 lds
  buffer_load_dwordx4 v27, s[20:23], s71 offen offset:1024 lds
  buffer_load_dwordx4 v28, s[20:23], s71 offen offset:2048 lds
  buffer_load_dwordx4 v29, s[20:23], s71 offen offset:3072 lds
  s_add_u32 m0, s45, 49152
  s_nop 0
  buffer_load_dwordx4 v30, s[16:19], s83 offen offset:0 lds
  buffer_load_dwordx4 v31, s[16:19], s83 offen offset:1024 lds
  buffer_load_dwordx4 v32, s[16:19], s83 offen offset:2048 lds
  buffer_load_dwordx4 v33, s[16:19], s83 offen offset:3072 lds
  s_add_u32 m0, s58, 0
  s_waitcnt vmcnt(16)
  s_barrier
  buffer_load_dwordx4 v26, s[20:23], s72 offen offset:0 lds
  buffer_load_dwordx4 v27, s[20:23], s72 offen offset:1024 lds
  buffer_load_dwordx4 v28, s[20:23], s72 offen offset:2048 lds
  buffer_load_dwordx4 v29, s[20:23], s72 offen offset:3072 lds
  s_add_u32 m0, s45, 0
  s_nop 0
  buffer_load_dwordx4 v30, s[16:19], s84 offen offset:0 lds
  buffer_load_dwordx4 v31, s[16:19], s84 offen offset:1024 lds
  buffer_load_dwordx4 v32, s[16:19], s84 offen offset:2048 lds
  buffer_load_dwordx4 v33, s[16:19], s84 offen offset:3072 lds
  s_load_dword s86, s[90:91], 1408
  s_load_dword s86, s[90:91], 1472
  s_load_dword s86, s[90:91], 1536
  s_load_dword s86, s[90:91], 1600
  s_load_dword s86, s[90:91], 1664
  s_load_dword s86, s[90:91], 1728
  s_load_dword s86, s[90:91], 1792
  s_load_dword s86, s[90:91], 1856
  s_load_dword s86, s[90:91], 1920
  s_load_dword s86, s[90:91], 1984
  s_add_u32 m0, s58, 16384
  s_waitcnt vmcnt(16)
  s_barrier
  buffer_load_dwordx4 v26, s[20:23], s73 offen offset:0 lds
  buffer_load_dwordx4 v27, s[20:23], s73 offen offset:1024 lds
  buffer_load_dwordx4 v28, s[20:23], s73 offen offset:2048 lds
  buffer_load_dwordx4 v29, s[20:23], s73 offen offset:3072 lds
  s_add_u32 m0, s45, 16384
  s_nop 0
  buffer_load_dwordx4 v30, s[16:19], s85 offen offset:0 lds
  buffer_load_dwordx4 v31, s[16:19], s85 offen offset:1024 lds
  buffer_load_dwordx4 v32, s[16:19], s85 offen offset:2048 lds
  buffer_load_dwordx4 v33, s[16:19], s85 offen offset:3072 lds
  s_add_u32 m0, s58, 32768
  s_waitcnt vmcnt(16)
  s_barrier
  buffer_load_dwordx4 v26, s[20:23], s74 offen offset:0 lds
  buffer_load_dwordx4 v27, s[20:23], s74 offen offset:1024 lds
  buffer_load_dwordx4 v28, s[20:23], s74 offen offset:2048 lds
  buffer_load_dwordx4 v29, s[20:23], s74 offen offset:3072 lds
  s_add_u32 m0, s45, 32768
  s_nop 0
  buffer_load_dwordx4 v30, s[16:19], s92 offen offset:0 lds
  buffer_load_dwordx4 v31, s[16:19], s92 offen offset:1024 lds
  buffer_load_dwordx4 v32, s[16:19], s92 offen offset:2048 lds
  buffer_load_dwordx4 v33, s[16:19], s92 offen offset:3072 lds
  s_add_u32 m0, s58, 49152
  s_waitcnt vmcnt(16)
  s_barrier
  buffer_load_dwordx4 v26, s[20:23], s75 offen offset:0 lds
  buffer_load_dwordx4 v27, s[20:23], s75 offen offset:1024 lds
  buffer_load_dwordx4 v28, s[20:23], s75 offen offset:2048 lds
  buffer_load_dwordx4 v29, s[20:23], s75 offen offset:3072 lds
  s_add_u32 m0, s45, 49152
  s_nop 0
  buffer_load_dwordx4 v30, s[16:19], s93 offen offset:0 lds
  buffer_load_dwordx4 v31, s[16:19], s93 offen offset:1024 lds
  buffer_load_dwordx4 v32, s[16:19], s93 offen offset:2048 lds
  buffer_load_dwordx4 v33, s[16:19], s93 offen offset:3072 lds
  s_mov_b32 s50, 1
  s_lshl_b32 s47, s52, 14
  s_add_u32 s47, s47, s59
  s_add_u32 s43, s47, 0
  v_add_u32 v26, s43, v10
  s_add_u32 s43, s47, 31744
  v_add_u32 v27, s43, v10
  s_add_u32 s43, s47, 6144
  v_add_u32 v28, s43, v11
  s_add_u32 s43, s47, 37888
  v_add_u32 v29, s43, v11
  v_lshrrev_b32 v25, 1, v252
  v_add_u32 v24, s97, v25
  v_subrev_u32 v24, 1, v24
  v_cmp_le_u32 vcc, 7, v24
  v_subrev_u32 v22, 7, v24
  s_nop 0
  v_cndmask_b32 v24, v24, v22, vcc
  v_add_u32 v24, 1, v24
  v_cmp_gt_u32 vcc, 1, v25
  s_nop 1
  v_cndmask_b32 v24, v24, v25, vcc
  v_add_u32 v24, s42, v24
  v_and_b32 v24, 7, v24
  v_lshlrev_b32 v24, 1, v24
  v_and_b32 v25, 1, v252
  v_add_u32 v25, v24, v25
  v_lshlrev_b32 v22, 14, v25
  v_lshlrev_b32 v23, 17, v25
  v_lshlrev_b32 v24, 1, v24
  s_and_b32 s47, s44, 2
  v_add_u32 v24, s47, v24
  v_readlane_b32 s60, v23, 0
  v_readlane_b32 s61, v23, 1
  v_readlane_b32 s62, v23, 2
  v_readlane_b32 s63, v23, 3
  v_readlane_b32 s64, v23, 4
  v_readlane_b32 s65, v23, 5
  v_readlane_b32 s66, v23, 6
  v_readlane_b32 s67, v23, 7
  v_readlane_b32 s68, v23, 8
  v_readlane_b32 s69, v23, 9
  v_readlane_b32 s70, v23, 10
  v_readlane_b32 s71, v23, 11
  v_readlane_b32 s72, v23, 12
  v_readlane_b32 s73, v23, 13
  v_readlane_b32 s74, v23, 14
  v_readlane_b32 s75, v23, 15
  v_readlane_b32 s34, v22, 2
  v_readlane_b32 s35, v22, 3
  v_readlane_b32 s76, v22, 4
  v_readlane_b32 s77, v22, 5
  v_readlane_b32 s78, v22, 6
  v_readlane_b32 s79, v22, 7
  v_readlane_b32 s80, v22, 8
  v_readlane_b32 s81, v22, 9
  v_readlane_b32 s82, v22, 10
  v_readlane_b32 s83, v22, 11
  v_readlane_b32 s84, v22, 12
  v_readlane_b32 s85, v22, 13
  v_readlane_b32 s92, v22, 14
  v_readlane_b32 s93, v22, 15
  s_nop 4
  v_readlane_b32 s47, v24, 2
  s_nop 3
  s_mov_b32 s94, s47
  s_add_u32 s95, s47, 1
  s_and_b32 s47, s44, 2
  s_lshl_b32 s98, 0x33333333, s47
  s_lshl_b32 s55, s41, 8
  s_add_u32 s55, s55, 50331648
  s_lshl_b32 s48, s41, 2
  s_add_u32 s48, s48, 128
  buffer_load_dword v9, v7, s[36:39], s48 offen sc1
  s_add_u32 s20, s20, 2097152
  s_addc_u32 s21, s21, 0
  s_sub_u32 s22, s22, 2097152
  s_add_u32 s47, s50, 1
  s_cmp_lt_u32 s47, 6
  s_cselect_b32 s47, 2097152, 0
  s_add_u32 s90, s90, s47
  s_addc_u32 s91, s91, 0
  s_add_u32 m0, s58, 0
  s_waitcnt vmcnt(16)
  s_barrier
  buffer_load_dwordx4 v26, s[20:23], s60 offen offset:0 lds
  buffer_load_dwordx4 v27, s[20:23], s60 offen offset:1024 lds
  buffer_load_dwordx4 v28, s[20:23], s60 offen offset:2048 lds
  buffer_load_dwordx4 v29, s[20:23], s60 offen offset:3072 lds
  s_add_u32 m0, s58, 16384
  s_waitcnt vmcnt(12)
  s_barrier
  buffer_load_dwordx4 v26, s[20:23], s61 offen offset:0 lds
  buffer_load_dwordx4 v27, s[20:23], s61 offen offset:1024 lds
  buffer_load_dwordx4 v28, s[20:23], s61 offen offset:2048 lds
  buffer_load_dwordx4 v29, s[20:23], s61 offen offset:3072 lds
  s_mov_b32 s51, 200000
L_arr:
  s_waitcnt vmcnt(0)
  v_readfirstlane_b32 s47, v9
  s_nop 3
  s_getreg_b32 s87, hwreg(HW_REG_XCC_ID, 0, 3)
  s_lshl_b32 s87, s87, 2
  s_lshl_b32 s87, 8, s87
  s_cmp_eq_u32 s47, s87
  s_cselect_b32 s87, 1, 0
  s_and_b32 s43, s47, 0x0f0f0f0f
  s_lshr_b32 s47, s47, 4
  s_and_b32 s47, s47, 0x0f0f0f0f
  s_add_u32 s47, s47, s43
  s_mul_i32 s47, s47, 0x01010101
  s_lshr_b32 s47, s47, 24
  s_cmp_ge_u32 s47, 8
  s_cbranch_scc1 L_join14
  s_cmp_eq_u32 s51, 0
  s_cbranch_scc1 L_join14
  s_sub_u32 s51, s51, 1
  buffer_load_dword v9, v7, s[36:39], s48 offen sc1
  s_branch L_arr
L_join14:
  s_sub_u32 s46, s50, 1
  s_and_b32 s47, s46, 1
  s_cmp_eq_u32 s87, 0
  s_cselect_b32 s46, s46, s47
  s_lshl_b32 s46, s46, 23
  s_lshl_b32 s47, s41, 18
  s_add_u32 s46, s46, s47
  s_add_u32 s46, s46, s45
  s_add_u32 m0, s58, 32768
  s_waitcnt vmcnt(8)
  s_barrier
  buffer_load_dwordx4 v26, s[20:23], s62 offen offset:0 lds
  buffer_load_dwordx4 v27, s[20:23], s62 offen offset:1024 lds
  buffer_load_dwordx4 v28, s[20:23], s62 offen offset:2048 lds
  buffer_load_dwordx4 v29, s[20:23], s62 offen offset:3072 lds
  s_add_u32 s28, s14, s46
  s_addc_u32 s29, s15, 0
  s_and_b32 s29, s29, 0xffff
  s_sub_u32 s30, 262144, s45
  s_mov_b32 s31, 0x00020000
  s_mov_b32 s51, 200000
  s_waitcnt vmcnt(8)
  s_barrier
  s_barrier
  s_mov_b32 exec_hi, 0
  buffer_load_dword v12, v6, s[24:27], s55 offen sc1
  buffer_load_dword v13, v6, s[24:27], s55 offen sc1
  s_waitcnt vmcnt(6)
  s_barrier
L_pp:
  s_waitcnt vmcnt(1)
  v_readlane_b32 s47, v12, s94
  v_readlane_b32 s49, v12, s95
  s_nop 1
  s_min_u32 s47, s47, s49
  s_cmp_ge_u32 s47, s50
  s_cbranch_scc1 L_ppdone
  buffer_load_dword v12, v6, s[24:27], s55 offen sc1
  s_waitcnt vmcnt(1)
  v_readlane_b32 s47, v13, s94
  v_readlane_b32 s49, v13, s95
  s_nop 1
  s_min_u32 s47, s47, s49
  s_cmp_ge_u32 s47, s50
  s_cbranch_scc1 L_ppdone
  buffer_load_dword v13, v6, s[24:27], s55 offen sc1
  s_cmp_eq_u32 s51, 0
  s_cbranch_scc1 L_ppdone
  s_sub_u32 s51, s51, 1
  s_branch L_pp
L_ppdone:
  s_mov_b64 exec, -1
  s_add_u32 m0, s45, 32768
  s_nop 0
  buffer_load_dwordx4 v5, s[28:31], s34 offen offset:0 sc1 lds
  buffer_load_dwordx4 v5, s[28:31], s34 offen offset:1024 sc1 lds
  buffer_load_dwordx4 v5, s[28:31], s34 offen offset:2048 sc1 lds
  buffer_load_dwordx4 v5, s[28:31], s34 offen offset:3072 sc1 lds
  s_mov_b32 exec_hi, 0
  buffer_load_dword v8, v6, s[24:27], s55 offen sc1
  s_mov_b64 exec, -1
  s_add_u32 m0, s45, 49152
  s_nop 0
  buffer_load_dwordx4 v5, s[28:31], s35 offen offset:0 sc1 lds
  buffer_load_dwordx4 v5, s[28:31], s35 offen offset:1024 sc1 lds
  buffer_load_dwordx4 v5, s[28:31], s35 offen offset:2048 sc1 lds
  buffer_load_dwordx4 v5, s[28:31], s35 offen offset:3072 sc1 lds
  s_add_u32 m0, s58, 49152
  s_nop 0
  buffer_load_dwordx4 v26, s[20:23], s63 offen offset:0 lds
  buffer_load_dwordx4 v27, s[20:23], s63 offen offset:1024 lds
  buffer_load_dwordx4 v28, s[20:23], s63 offen offset:2048 lds
  buffer_load_dwordx4 v29, s[20:23], s63 offen offset:3072 lds
  s_add_u32 m0, s58, 0
  s_waitcnt vmcnt(8)
  s_barrier
  buffer_load_dwordx4 v26, s[20:23], s64 offen offset:0 lds
  buffer_load_dwordx4 v27, s[20:23], s64 offen offset:1024 lds
  buffer_load_dwordx4 v28, s[20:23], s64 offen offset:2048 lds
  buffer_load_dwordx4 v29, s[20:23], s64 offen offset:3072 lds
  v_cmp_le_u32 vcc, s50, v8
  s_nop 1
  s_and_b32 s47, vcc_lo, s98
  s_cmp_eq_u32 s47, s98
  s_cbranch_scc0 L_checked
  s_add_u32 m0, s45, 0
  s_nop 0
  buffer_load_dwordx4 v5, s[28:31], s76 offen offset:0 sc1 lds
  buffer_load_dwordx4 v5, s[28:31], s76 offen offset:1024 sc1 lds
  buffer_load_dwordx4 v5, s[28:31], s76 offen offset:2048 sc1 lds
  buffer_load_dwordx4 v5, s[28:31], s76 offen offset:3072 sc1 lds
  s_add_u32 m0, s58, 16384
  s_waitcnt vmcnt(8)
  s_barrier
  buffer_load_dwordx4 v26, s[20:23], s65 offen offset:0 lds
  buffer_load_dwordx4 v27, s[20:23], s65 offen offset:1024 lds
  buffer_load_dwordx4 v28, s[20:23], s65 offen offset:2048 lds
  buffer_load_dwordx4 v29, s[20:23], s65 offen offset:3072 lds
  s_add_u32 m0, s45, 16384
  s_nop 0
  buffer_load_dwordx4 v5, s[28:31], s77 offen offset:0 sc1 lds
  buffer_load_dwordx4 v5, s[28:31], s77 offen offset:1024 sc1 lds
  buffer_load_dwordx4 v5, s[28:31], s77 offen offset:2048 sc1 lds
  buffer_load_dwordx4 v5, s[28:31], s77 offen offset:3072 sc1 lds
  s_load_dword s86, s[90:91], 0
  s_load_dword s86, s[90:91], 64
  s_load_dword s86, s[90:91], 128
  s_load_dword s86, s[90:91], 192
  s_load_dword s86, s[90:91], 256
  s_load_dword s86, s[90:91], 320
  s_load_dword s86, s[90:91], 384
  s_load_dword s86, s[90:91], 448
  s_load_dword s86, s[90:91], 512
  s_load_dword s86, s[90:91], 576
  s_load_dword s86, s[90:91], 640
  s_add_u32 m0, s58, 32768
  s_waitcnt vmcnt(8)
  s_barrier
  buffer_load_dwordx4 v26, s[20:23], s66 offen offset:0 lds
  buffer_load_dwordx4 v27, s[20:23], s66 offen offset:1024 lds
  buffer_load_dwordx4 v28, s[20:23], s66 offen offset:2048 lds
  buffer_load_dwordx4 v29, s[20:23], s66 offen offset:3072 lds
  s_add_u32 m0, s45, 32768
  s_nop 0
  buffer_load_dwordx4 v5, s[28:31], s78 offen offset:0 sc1 lds
  buffer_load_dwordx4 v5, s[28:31], s78 offen offset:1024 sc1 lds
  buffer_load_dwordx4 v5, s[28:31], s78 offen offset:2048 sc1 lds
  buffer_load_dwordx4 v5, s[28:31], s78 offen offset:3072 sc1 lds
  s_add_u32 m0, s58, 49152
  s_waitcnt vmcnt(8)
  s_barrier
  buffer_load_dwordx4 v26, s[20:23], s67 offen offset:0 lds
  buffer_load_dwordx4 v27, s[20:23], s67 offen offset:1024 lds
  buffer_load_dwordx4 v28, s[20:23], s67 offen offset:2048 lds
  buffer_load_dwordx4 v29, s[20:23], s67 offen offset:3072 lds
  s_add_u32 m0, s45, 49152
  s_nop 0
  buffer_load_dwordx4 v5, s[28:31], s79 offen offset:0 sc1 lds
  buffer_load_dwordx4 v5, s[28:31], s79 offen offset:1024 sc1 lds
  buffer_load_dwordx4 v5, s[28:31], s79 offen offset:2048 sc1 lds
  buffer_load_dwordx4 v5, s[28:31], s79 offen offset:3072 sc1 lds
  s_add_u32 m0, s58, 0
  s_waitcnt vmcnt(8)
  s_barrier
  buffer_load_dwordx4 v26, s[20:23], s68 offen offset:0 lds
  buffer_load_dwordx4 v27, s[20:23], s68 offen offset:1024 lds
  buffer_load_dwordx4 v28, s[20:23], s68 offen offset:2048 lds
  buffer_load_dwordx4 v29, s[20:23], s68 offen offset:3072 lds
  s_add_u32 m0, s45, 0
  s_nop 0
  buffer_load_dwordx4 v5, s[28:31], s80 offen offset:0 sc1 lds
  buffer_load_dwordx4 v5, s[28:31], s80 offen offset:1024 sc1 lds
  buffer_load_dwordx4 v5, s[28:31], s80 offen offset:2048 sc1 lds
  buffer_load_dwordx4 v5, s[28:31], s80 offen offset:3072 sc1 lds
  s_add_u32 m0, s58, 16384
  s_waitcnt vmcnt(8)
  s_barrier
  buffer_load_dwordx4 v26, s[20:23], s69 offen offset:0 lds
  buffer_load_dwordx4 v27, s[20:23], s69 offen offset:1024 lds
  buffer_load_dwordx4 v28, s[20:23], s69 offen offset:2048 lds
  buffer_load_dwordx4 v29, s[20:23], s69 offen offset:3072 lds
  s_add_u32 m0, s45, 16384
  s_nop 0
  buffer_load_dwordx4 v5, s[28:31], s81 offen offset:0 sc1 lds
  buffer_load_dwordx4 v5, s[28:31], s81 offen offset:1024 sc1 lds
  buffer_load_dwordx4 v5, s[28:31], s81 offen offset:2048 sc1 lds
  buffer_load_dwordx4 v5, s[28:31], s81 offen offset:3072 sc1 lds
  s_load_dword s86, s[90:91], 704
  s_load_dword s86, s[90:91], 768
  s_load_dword s86, s[90:91], 832
  s_load_dword s86, s[90:91], 896
  s_load_dword s86, s[90:91], 960
  s_load_dword s86, s[90:91], 1024
  s_load_dword s86, s[90:91], 1088
  s_load_dword s86, s[90:91], 1152
  s_load_dword s86, s[90:91], 1216
  s_load_dword s86, s[90:91], 1280
  s_load_dword s86, s[90:91], 1344
  s_add_u32 m0, s58, 32768
  s_waitcnt vmcnt(8)
  s_barrier
  buffer_load_dwordx4 v26, s[20:23], s70 offen offset:0 lds
  buffer_load_dwordx4 v27, s[20:23], s70 offen offset:1024 lds
  buffer_load_dwordx4 v28, s[20:23], s70 offen offset:2048 lds
  buffer_load_dwordx4 v29, s[20:23], s70 offen offset:3072 lds
  s_add_u32 m0, s45, 32768
  s_nop 0
  buffer_load_dwordx4 v5, s[28:31], s82 offen offset:0 sc1 lds
  buffer_load_dwordx4 v5, s[28:31], s82 offen offset:1024 sc1 lds
  buffer_load_dwordx4 v5, s[28:31], s82 offen offset:2048 sc1 lds
  buffer_load_dwordx4 v5, s[28:31], s82 offen offset:3072 sc1 lds
  s_add_u32 m0, s58, 49152
  s_waitcnt vmcnt(8)
  s_barrier
  buffer_load_dwordx4 v26, s[20:23], s71 offen offset:0 lds
  buffer_load_dwordx4 v27, s[20:23], s71 offen offset:1024 lds
  buffer_load_dwordx4 v28, s[20:23], s71 offen offset:2048 lds
  buffer_load_dwordx4 v29, s[20:23], s71 offen offset:3072 lds
  s_add_u32 m0, s45, 49152
  s_nop 0
  buffer_load_dwordx4 v5, s[28:31], s83 offen offset:0 sc1 lds
  buffer_load_dwordx4 v5, s[28:31], s83 offen offset:1024 sc1 lds
  buffer_load_dwordx4 v5, s[28:31], s83 offen offset:2048 sc1 lds
  buffer_load_dwordx4 v5, s[28:31], s83 offen offset:3072 sc1 lds
  s_add_u32 m0, s58, 0
  s_waitcnt vmcnt(8)
  s_barrier
  buffer_load_dwordx4 v26, s[20:23], s72 offen offset:0 lds
  buffer_load_dwordx4 v27, s[20:23], s72 offen offset:1024 lds
  buffer_load_dwordx4 v28, s[20:23], s72 offen offset:2048 lds
  buffer_load_dwordx4 v29, s[20:23], s72 offen offset:3072 lds
  s_add_u32 m0, s45, 0
  s_nop 0
  buffer_load_dwordx4 v5, s[28:31], s84 offen offset:0 sc1 lds
  buffer_load_dwordx4 v5, s[28:31], s84 offen offset:1024 sc1 lds
  buffer_load_dwordx4 v5, s[28:31], s84 offen offset:2048 sc1 lds
  buffer_load_dwordx4 v5, s[28:31], s84 offen offset:3072 sc1 lds
  s_add_u32 m0, s58, 16384
  s_waitcnt vmcnt(8)
  s_barrier
  buffer_load_dwordx4 v26, s[20:23], s73 offen offset:0 lds
  buffer_load_dwordx4 v27, s[20:23], s73 offen offset:1024 lds
  buffer_load_dwordx4 v28, s[20:23], s73 offen offset:2048 lds
  buffer_load_dwordx4 v29, s[20:23], s73 offen offset:3072 lds
  s_add_u32 m0, s45, 16384
  s_nop 0
  buffer_load_dwordx4 v5, s[28:31], s85 offen offset:0 sc1 lds
  buffer_load_dwordx4 v5, s[28:31], s85 offen offset:1024 sc1 lds
  buffer_load_dwordx4 v5, s[28:31], s85 offen offset:2048 sc1 lds
  buffer_load_dwordx4 v5, s[28:31], s85 offen offset:3072 sc1 lds
  s_load_dword s86, s[90:91], 1408
  s_load_dword s86, s[90:91], 1472
  s_load_dword s86, s[90:91], 1536
  s_load_dword s86, s[90:91], 1600
  s_load_dword s86, s[90:91], 1664
  s_load_dword s86, s[90:91], 1728
  s_load_dword s86, s[90:91], 1792
  s_load_dword s86, s[90:91], 1856
  s_load_dword s86, s[90:91], 1920
  s_load_dword s86, s[90:91], 1984
  s_add_u32 m0, s58, 32768
  s_waitcnt vmcnt(8)
  s_barrier
  buffer_load_dwordx4 v26, s[20:23], s74 offen offset:0 lds
  buffer_load_dwordx4 v27, s[20:23], s74 offen offset:1024 lds
  buffer_load_dwordx4 v28, s[20:23], s74 offen offset:2048 lds
  buffer_load_dwordx4 v29, s[20:23], s74 offen offset:3072 lds
  s_add_u32 m0, s45, 32768
  s_nop 0
  buffer_load_dwordx4 v5, s[28:31], s92 offen offset:0 sc1 lds
  buffer_load_dwordx4 v5, s[28:31], s92 offen offset:1024 sc1 lds
  buffer_load_dwordx4 v5, s[28:31], s92 offen offset:2048 sc1 lds
  buffer_load_dwordx4 v5, s[28:31], s92 offen offset:3072 sc1 lds
  s_add_u32 m0, s58, 49152
  s_waitcnt vmcnt(8)
  s_barrier
  buffer_load_dwordx4 v26, s[20:23], s75 offen offset:0 lds
  buffer_load_dwordx4 v27, s[20:23], s75 offen offset:1024 lds
  buffer_load_dwordx4 v28, s[20:23], s75 offen offset:2048 lds
  buffer_load_dwordx4 v29, s[20:23], s75 offen offset:3072 lds
  s_add_u32 m0, s45, 49152
  s_nop 0
  buffer_load_dwordx4 v5, s[28:31], s93 offen offset:0 sc1 lds
  buffer_load_dwordx4 v5, s[28:31], s93 offen offset:1024 sc1 lds
  buffer_load_dwordx4 v5, s[28:31], s93 offen offset:2048 sc1 lds
  buffer_load_dwordx4 v5, s[28:31], s93 offen offset:3072 sc1 lds
L_layerend:
  s_add_u32 s50, s50, 1
  s_cmp_eq_u32 s50, 6
  s_cbranch_scc1 L_llast
  s_add_u32 s20, s20, 2097152
  s_addc_u32 s21, s21, 0
  s_sub_u32 s22, s22, 2097152
  s_add_u32 s47, s50, 1
  s_cmp_lt_u32 s47, 6
  s_cselect_b32 s47, 2097152, 0
  s_add_u32 s90, s90, s47
  s_addc_u32 s91, s91, 0
  s_add_u32 m0, s58, 0
  s_waitcnt vmcnt(8)
  s_barrier
  buffer_load_dwordx4 v26, s[20:23], s60 offen offset:0 lds
  buffer_load_dwordx4 v27, s[20:23], s60 offen offset:1024 lds
  buffer_load_dwordx4 v28, s[20:23], s60 offen offset:2048 lds
  buffer_load_dwordx4 v29, s[20:23], s60 offen offset:3072 lds
  s_add_u32 m0, s58, 16384
  s_nop 0
  buffer_load_dwordx4 v26, s[20:23], s61 offen offset:0 lds
  buffer_load_dwordx4 v27, s[20:23], s61 offen offset:1024 lds
  buffer_load_dwordx4 v28, s[20:23], s61 offen offset:2048 lds
  buffer_load_dwordx4 v29, s[20:23], s61 offen offset:3072 lds
  s_branch L_join14
L_checked:
  v_readlane_b32 s47, v24, 4
  s_nop 1
  s_mov_b32 s43, s47
  s_add_u32 s53, s47, 1
L_chk0:
  v_readlane_b32 s47, v8, s43
  v_readlane_b32 s49, v8, s53
  s_nop 1
  s_min_u32 s47, s47, s49
  s_cmp_ge_u32 s47, s50
  s_cbranch_scc1 L_ok0
  s_cmp_eq_u32 s51, 0
  s_cbranch_scc1 L_ok0
  s_mov_b32 exec_hi, 0
  buffer_load_dword v8, v6, s[24:27], s55 offen sc1
  s_sub_u32 s51, s51, 1
  s_waitcnt vmcnt(0)
  s_mov_b64 exec, -1
  s_branch L_chk0
L_ok0:
  s_add_u32 m0, s45, 0
  s_nop 0
  buffer_load_dwordx4 v5, s[28:31], s76 offen offset:0 sc1 lds
  buffer_load_dwordx4 v5, s[28:31], s76 offen offset:1024 sc1 lds
  buffer_load_dwordx4 v5, s[28:31], s76 offen offset:2048 sc1 lds
  buffer_load_dwordx4 v5, s[28:31], s76 offen offset:3072 sc1 lds
  s_add_u32 m0, s58, 16384
  s_waitcnt vmcnt(8)
  s_barrier
  buffer_load_dwordx4 v26, s[20:23], s65 offen offset:0 lds
  buffer_load_dwordx4 v27, s[20:23], s65 offen offset:1024 lds
  buffer_load_dwordx4 v28, s[20:23], s65 offen offset:2048 lds
  buffer_load_dwordx4 v29, s[20:23], s65 offen offset:3072 lds
  s_add_u32 m0, s45, 16384
  s_nop 0
  buffer_load_dwordx4 v5, s[28:31], s77 offen offset:0 sc1 lds
  buffer_load_dwordx4 v5, s[28:31], s77 offen offset:1024 sc1 lds
  buffer_load_dwordx4 v5, s[28:31], s77 offen offset:2048 sc1 lds
  buffer_load_dwordx4 v5, s[28:31], s77 offen offset:3072 sc1 lds
  s_load_dword s86, s[90:91], 0
  s_load_dword s86, s[90:91], 64
  s_load_dword s86, s[90:91], 128
  s_load_dword s86, s[90:91], 192
  s_load_dword s86, s[90:91], 256
  s_load_dword s86, s[90:91], 320
  s_load_dword s86, s[90:91], 384
  s_load_dword s86, s[90:91], 448
  s_load_dword s86, s[90:91], 512
  s_load_dword s86, s[90:91], 576
  s_load_dword s86, s[90:91], 640
  v_readlane_b32 s47, v24, 6
  s_nop 1
  s_mov_b32 s43, s47
  s_add_u32 s53, s47, 1
L_chk1:
  v_readlane_b32 s47, v8, s43
  v_readlane_b32 s49, v8, s53
  s_nop 1
  s_min_u32 s47, s47, s49
  s_cmp_ge_u32 s47, s50
  s_cbranch_scc1 L_ok1
  s_cmp_eq_u32 s51, 0
  s_cbranch_scc1 L_ok1
  s_mov_b32 exec_hi, 0
  buffer_load_dword v8, v6, s[24:27], s55 offen sc1
  s_sub_u32 s51, s51, 1
  s_waitcnt vmcnt(0)
  s_mov_b64 exec, -1
  s_branch L_chk1
L_ok1:
  s_add_u32 m0, s58, 32768
  s_waitcnt vmcnt(8)
  s_barrier
  buffer_load_dwordx4 v26, s[20:23], s66 offen offset:0 lds
  buffer_load_dwordx4 v27, s[20:23], s66 offen offset:1024 lds
  buffer_load_dwordx4 v28, s[20:23], s66 offen offset:2048 lds
  buffer_load_dwordx4 v29, s[20:23], s66 offen offset:3072 lds
  s_add_u32 m0, s45, 32768
  s_nop 0
  buffer_load_dwordx4 v5, s[28:31], s78 offen offset:0 sc1 lds
  buffer_load_dwordx4 v5, s[28:31], s78 offen offset:1024 sc1 lds
  buffer_load_dwordx4 v5, s[28:31], s78 offen offset:2048 sc1 lds
  buffer_load_dwordx4 v5, s[28:31], s78 offen offset:3072 sc1 lds
  s_add_u32 m0, s58, 49152
  s_waitcnt vmcnt(8)
  s_barrier
  buffer_load_dwordx4 v26, s[20:23], s67 offen offset:0 lds
  buffer_load_dwordx4 v27, s[20:23], s67 offen offset:1024 lds
  buffer_load_dwordx4 v28, s[20:23], s67 offen offset:2048 lds
  buffer_load_dwordx4 v29, s[20:23], s67 offen offset:3072 lds
  s_add_u32 m0, s45, 49152
  s_nop 0
  buffer_load_dwordx4 v5, s[28:31], s79 offen offset:0 sc1 lds
  buffer_load_dwordx4 v5, s[28:31], s79 offen offset:1024 sc1 lds
  buffer_load_dwordx4 v5, s[28:31], s79 offen offset:2048 sc1 lds
  buffer_load_dwordx4 v5, s[28:31], s79 offen offset:3072 sc1 lds
  v_readlane_b32 s47, v24, 8
  s_nop 1
  s_mov_b32 s43, s47
  s_add_u32 s53, s47, 1
L_chk2:
  v_readlane_b32 s47, v8, s43
  v_readlane_b32 s49, v8, s53
  s_nop 1
  s_min_u32 s47, s47, s49
  s_cmp_ge_u32 s47, s50
  s_cbranch_scc1 L_ok2
  s_cmp_eq_u32 s51, 0
  s_cbranch_scc1 L_ok2
  s_mov_b32 exec_hi, 0
  buffer_load_dword v8, v6, s[24:27], s55 offen sc1
  s_sub_u32 s51, s51, 1
  s_waitcnt vmcnt(0)
  s_mov_b64 exec, -1
  s_branch L_chk2
L_ok2:
  s_add_u32 m0, s58, 0
  s_waitcnt vmcnt(8)
  s_barrier
  buffer_load_dwordx4 v26, s[20:23], s68 offen offset:0 lds
  buffer_load_dwordx4 v27, s[20:23], s68 offen offset:1024 lds
  buffer_load_dwordx4 v28, s[20:23], s68 offen offset:2048 lds
  buffer_load_dwordx4 v29, s[20:23], s68 offen offset:3072 lds
  s_add_u32 m0, s45, 0
  s_nop 0
  buffer_load_dwordx4 v5, s[28:31], s80 offen offset:0 sc1 lds
  buffer_load_dwordx4 v5, s[28:31], s80 offen offset:1024 sc1 lds
  buffer_load_dwordx4 v5, s[28:31], s80 offen offset:2048 sc1 lds
  buffer_load_dwordx4 v5, s[28:31], s80 offen offset:3072 sc1 lds
  s_add_u32 m0, s58, 16384
  s_waitcnt vmcnt(8)
  s_barrier
  buffer_load_dwordx4 v26, s[20:23], s69 offen offset:0 lds
  buffer_load_dwordx4 v27, s[20:23], s69 offen offset:1024 lds
  buffer_load_dwordx4 v28, s[20:23], s69 offen offset:2048 lds
  buffer_load_dwordx4 v29, s[20:23], s69 offen offset:3072 lds
  s_add_u32 m0, s45, 16384
  s_nop 0
  buffer_load_dwordx4 v5, s[28:31], s81 offen offset:0 sc1 lds
  buffer_load_dwordx4 v5, s[28:31], s81 offen offset:1024 sc1 lds
  buffer_load_dwordx4 v5, s[28:31], s81 offen offset:2048 sc1 lds
  buffer_load_dwordx4 v5, s[28:31], s81 offen offset:3072 sc1 lds
  s_load_dword s86, s[90:91], 704
  s_load_dword s86, s[90:91], 768
  s_load_dword s86, s[90:91], 832
  s_load_dword s86, s[90:91], 896
  s_load_dword s86, s[90:91], 960
  s_load_dword s86, s[90:91], 1024
  s_load_dword s86, s[90:91], 1088
  s_load_dword s86, s[90:91], 1152
  s_load_dword s86, s[90:91], 1216
  s_load_dword s86, s[90:91], 1280
  s_load_dword s86, s[90:91], 1344
  v_readlane_b32 s47, v24, 10
  s_nop 1
  s_mov_b32 s43, s47
  s_add_u32 s53, s47, 1
L_chk3:
  v_readlane_b32 s47, v8, s43
  v_readlane_b32 s49, v8, s53
  s_nop 1
  s_min_u32 s47, s47, s49
  s_cmp_ge_u32 s47, s50
  s_cbranch_scc1 L_ok3
  s_cmp_eq_u32 s51, 0
  s_cbranch_scc1 L_ok3
  s_mov_b32 exec_hi, 0
  buffer_load_dword v8, v6, s[24:27], s55 offen sc1
  s_sub_u32 s51, s51, 1
  s_waitcnt vmcnt(0)
  s_mov_b64 exec, -1
  s_branch L_chk3
L_ok3:
  s_add_u32 m0, s58, 32768
  s_waitcnt vmcnt(8)
  s_barrier
  buffer_load_dwordx4 v26, s[20:23], s70 offen offset:0 lds
  buffer_load_dwordx4 v27, s[20:23], s70 offen offset:1024 lds
  buffer_load_dwordx4 v28, s[20:23], s70 offen offset:2048 lds
  buffer_load_dwordx4 v29, s[20:23], s70 offen offset:3072 lds
  s_add_u32 m0, s45, 32768
  s_nop 0
  buffer_load_dwordx4 v5, s[28:31], s82 offen offset:0 sc1 lds
  buffer_load_dwordx4 v5, s[28:31], s82 offen offset:1024 sc1 lds
  buffer_load_dwordx4 v5, s[28:31], s82 offen offset:2048 sc1 lds
  buffer_load_dwordx4 v5, s[28:31], s82 offen offset:3072 sc1 lds
  s_add_u32 m0, s58, 49152
  s_waitcnt vmcnt(8)
  s_barrier
  buffer_load_dwordx4 v26, s[20:23], s71 offen offset:0 lds
  buffer_load_dwordx4 v27, s[20:23], s71 offen offset:1024 lds
  buffer_load_dwordx4 v28, s[20:23], s71 offen offset:2048 lds
  buffer_load_dwordx4 v29, s[20:23], s71 offen offset:3072 lds
  s_add_u32 m0, s45, 49152
  s_nop 0
  buffer_load_dwordx4 v5, s[28:31], s83 offen offset:0 sc1 lds
  buffer_load_dwordx4 v5, s[28:31], s83 offen offset:1024 sc1 lds
  buffer_load_dwordx4 v5, s[28:31], s83 offen offset:2048 sc1 lds
  buffer_load_dwordx4 v5, s[28:31], s83 offen offset:3072 sc1 lds
  v_readlane_b32 s47, v24, 12
  s_nop 1
  s_mov_b32 s43, s47
  s_add_u32 s53, s47, 1
L_chk4:
  v_readlane_b32 s47, v8, s43
  v_readlane_b32 s49, v8, s53
  s_nop 1
  s_min_u32 s47, s47, s49
  s_cmp_ge_u32 s47, s50
  s_cbranch_scc1 L_ok4
  s_cmp_eq_u32 s51, 0
  s_cbranch_scc1 L_ok4
  s_mov_b32 exec_hi, 0
  buffer_load_dword v8, v6, s[24:27], s55 offen sc1
  s_sub_u32 s51, s51, 1
  s_waitcnt vmcnt(0)
  s_mov_b64 exec, -1
  s_branch L_chk4
L_ok4:
  s_add_u32 m0, s58, 0
  s_waitcnt vmcnt(8)
  s_barrier
  buffer_load_dwordx4 v26, s[20:23], s72 offen offset:0 lds
  buffer_load_dwordx4 v27, s[20:23], s72 offen offset:1024 lds
  buffer_load_dwordx4 v28, s[20:23], s72 offen offset:2048 lds
  buffer_load_dwordx4 v29, s[20:23], s72 offen offset:3072 lds
  s_add_u32 m0, s45, 0
  s_nop 0
  buffer_load_dwordx4 v5, s[28:31], s84 offen offset:0 sc1 lds
  buffer_load_dwordx4 v5, s[28:31], s84 offen offset:1024 sc1 lds
  buffer_load_dwordx4 v5, s[28:31], s84 offen offset:2048 sc1 lds
  buffer_load_dwordx4 v5, s[28:31], s84 offen offset:3072 sc1 lds
  s_add_u32 m0, s58, 16384
  s_waitcnt vmcnt(8)
  s_barrier
  buffer_load_dwordx4 v26, s[20:23], s73 offen offset:0 lds
  buffer_load_dwordx4 v27, s[20:23], s73 offen offset:1024 lds
  buffer_load_dwordx4 v28, s[20:23], s73 offen offset:2048 lds
  buffer_load_dwordx4 v29, s[20:23], s73 offen offset:3072 lds
  s_add_u32 m0, s45, 16384
  s_nop 0
  buffer_load_dwordx4 v5, s[28:31], s85 offen offset:0 sc1 lds
  buffer_load_dwordx4 v5, s[28:31], s85 offen offset:1024 sc1 lds
  buffer_load_dwordx4 v5, s[28:31], s85 offen offset:2048 sc1 lds
  buffer_load_dwordx4 v5, s[28:31], s85 offen offset:3072 sc1 lds
  s_load_dword s86, s[90:91], 1408
  s_load_dword s86, s[90:91], 1472
  s_load_dword s86, s[90:91], 1536
  s_load_dword s86, s[90:91], 1600
  s_load_dword s86, s[90:91], 1664
  s_load_dword s86, s[90:91], 1728
  s_load_dword s86, s[90:91], 1792
  s_load_dword s86, s[90:91], 1856
  s_load_dword s86, s[90:91], 1920
  s_load_dword s86, s[90:91], 1984
  v_readlane_b32 s47, v24, 14
  s_nop 1
  s_mov_b32 s43, s47
  s_add_u32 s53, s47, 1
L_chk5:
  v_readlane_b32 s47, v8, s43
  v_readlane_b32 s49, v8, s53
  s_nop 1
  s_min_u32 s47, s47, s49
  s_cmp_ge_u32 s47, s50
  s_cbranch_scc1 L_ok5
  s_cmp_eq_u32 s51, 0
  s_cbranch_scc1 L_ok5
  s_mov_b32 exec_hi, 0
  buffer_load_dword v8, v6, s[24:27], s55 offen sc1
  s_sub_u32 s51, s51, 1
  s_waitcnt vmcnt(0)
  s_mov_b64 exec, -1
  s_branch L_chk5
L_ok5:
  s_add_u32 m0, s58, 32768
  s_waitcnt vmcnt(8)
  s_barrier
  buffer_load_dwordx4 v26, s[20:23], s74 offen offset:0 lds
  buffer_load_dwordx4 v27, s[20:23], s74 offen offset:1024 lds
  buffer_load_dwordx4 v28, s[20:23], s74 offen offset:2048 lds
  buffer_load_dwordx4 v29, s[20:23], s74 offen offset:3072 lds
  s_add_u32 m0, s45, 32768
  s_nop 0
  buffer_load_dwordx4 v5, s[28:31], s92 offen offset:0 sc1 lds
  buffer_load_dwordx4 v5, s[28:31], s92 offen offset:1024 sc1 lds
  buffer_load_dwordx4 v5, s[28:31], s92 offen offset:2048 sc1 lds
  buffer_load_dwordx4 v5, s[28:31], s92 offen offset:3072 sc1 lds
  s_add_u32 m0, s58, 49152
  s_waitcnt vmcnt(8)
  s_barrier
  buffer_load_dwordx4 v26, s[20:23], s75 offen offset:0 lds
  buffer_load_dwordx4 v27, s[20:23], s75 offen offset:1024 lds
  buffer_load_dwordx4 v28, s[20:23], s75 offen offset:2048 lds
  buffer_load_dwordx4 v29, s[20:23], s75 offen offset:3072 lds
  s_add_u32 m0, s45, 49152
  s_nop 0
  buffer_load_dwordx4 v5, s[28:31], s93 offen offset:0 sc1 lds
  buffer_load_dwordx4 v5, s[28:31], s93 offen offset:1024 sc1 lds
  buffer_load_dwordx4 v5, s[28:31], s93 offen offset:2048 sc1 lds
  buffer_load_dwordx4 v5, s[28:31], s93 offen offset:3072 sc1 lds
  s_branch L_layerend
L_llast:
  s_waitcnt vmcnt(8)
  s_barrier
  s_waitcnt vmcnt(0)
  s_barrier
  s_barrier
L_done:
L_end:
  s_endpgm
.section .rodata,"a"
.p2align 6
.amdhsa_kernel standalone__dcn_v2_cross__recsys_kernel
  .amdhsa_next_free_vgpr 256
  .amdhsa_next_free_sgpr 102
  .amdhsa_accum_offset 256
  .amdhsa_group_segment_fixed_size 0
  .amdhsa_kernarg_size 48
  .amdhsa_user_sgpr_count 2
  .amdhsa_user_sgpr_kernarg_segment_ptr 1
  .amdhsa_system_sgpr_workgroup_id_x 1
.end_amdhsa_kernel
```
